```python
import torch

def _softmax(x, axis=-1):
    return torch.softmax(x, dim=axis)
def _gelu(x):
    return torch.nn.functional.gelu(x, approximate="tanh")
def _silu(x):
    return torch.nn.functional.silu(x)
def _sigmoid(x):
    return torch.sigmoid(x)
def _layernorm(x, axis=-1, eps=1e-5):
    m = x.mean(dim=axis, keepdim=True)
    v = x.var(dim=axis, keepdim=True, unbiased=False)
    return (x - m) / torch.sqrt(v + eps)
def _scatter_add(tgt, idx, src, axis=0):
    return tgt.clone().index_add_(axis, idx, src)
def _segment_sum(src, seg, n):
    out = torch.zeros((n,) + src.shape[1:], dtype=src.dtype)
    return out.index_add_(0, seg, src)
def _pad(x, pw):
    flat = tuple(v for pair in reversed(pw) for v in pair)
    return torch.nn.functional.pad(x, flat)

kernel_name = 'concat_heads__sliding_block_cached__mha_block_cached__decode'

def setup_inputs():

    _w = (lambda a: (lambda t: t.to(torch.bfloat16) if t.is_floating_point() else t)(torch.as_tensor(a)))
    def _A_setup():
        B, Sq, D = 1, 1, 1024
        Hq, Hkv, Sk, Dh = 32, 4, 32768, 128
        assert Hq % Hkv == 0, (Hq, Hkv)
        return {
            "x": _w((lambda *s: torch.randn(*s, dtype=torch.bfloat16) * 0.8)(B, Sq, D)),
            "k_cache": _w((lambda *s: torch.randn(*s, dtype=torch.bfloat16) * 1.6)(B, Hkv, Sk, Dh)),
            "v_cache": _w((lambda *s: torch.randn(*s, dtype=torch.bfloat16) * 0.2)(B, Hkv, Sk, Dh)),
            "wq": _w((lambda *s: torch.randn(*s, dtype=torch.bfloat16) * 1.6)(D, Hq * Dh) * (D ** -0.5)),
            "wo": _w((lambda *s: torch.randn(*s, dtype=torch.bfloat16) * 0.2)(Hq * Dh, D) * ((Hq * Dh) ** -0.5)),
        }
    _A_in = _A_setup()

    def _B_setup():
        B, Sq, D = 1, 1, 1024
        H, Sk, Dh = 32, 32768, 128
        return {
            "x": _w((lambda *s: torch.randn(*s, dtype=torch.bfloat16) * 0.8)(B, Sq, D)),
            "k_cache": _w((lambda *s: torch.randn(*s, dtype=torch.bfloat16) * 1.6)(B, H, Sk, Dh)),
            "v_cache": _w((lambda *s: torch.randn(*s, dtype=torch.bfloat16) * 0.2)(B, H, Sk, Dh)),
            "wq": _w((lambda *s: torch.randn(*s, dtype=torch.bfloat16) * 1.6)(D, H * Dh) * (D ** -0.5)),
            "wo": _w((lambda *s: torch.randn(*s, dtype=torch.bfloat16) * 0.2)(H * Dh, D) * ((H * Dh) ** -0.5)),
        }
    _B_in = _B_setup()

    return {
        "A_x": _A_in["x"],
        "A_k_cache": _A_in["k_cache"],
        "A_v_cache": _A_in["v_cache"],
        "A_wq": _A_in["wq"],
        "A_wo": _A_in["wo"],
        "B_x": _B_in["x"],
        "B_k_cache": _B_in["k_cache"],
        "B_v_cache": _B_in["v_cache"],
        "B_wq": _B_in["wq"],
        "B_wo": _B_in["wo"],
    }

def reference(A_x, A_k_cache, A_v_cache, A_wq, A_wo, B_x, B_k_cache, B_v_cache, B_wq, B_wo):
    def _A_ref(x, k_cache, v_cache, wq, wo):
        B, Sq, D = x.shape
        Hq, Dh = 32, 128
        Hkv, Sk = k_cache.shape[1], k_cache.shape[2]
        W = min(4096, max(256, Sk // 4))
        rep = Hq // Hkv
        q = (lambda x, *d: x.permute(*d))((x @ wq).reshape(B, Sq, Hq, Dh), 0, 2, 1, 3)
        k = (lambda x, n, axis: torch.repeat_interleave(x, n, dim=axis))(k_cache[:, :, Sk - W:, :], rep, axis=1)
        v = (lambda x, n, axis: torch.repeat_interleave(x, n, dim=axis))(v_cache[:, :, Sk - W:, :], rep, axis=1)
        scores = torch.einsum("bhqd,bhkd->bhqk", q, k) * (Dh ** -0.5)
        p = _softmax(scores, axis=-1)
        o = torch.einsum("bhqk,bhkd->bhqd", p, v)
        return (lambda x, *d: x.permute(*d))(o, 0, 2, 1, 3).reshape(B, Sq, Hq * Dh) @ wo

    def _B_ref(x, k_cache, v_cache, wq, wo):
        B, Sq, D = x.shape
        H, Dh = 32, 128
        q = (lambda x, *d: x.permute(*d))((x @ wq).reshape(B, Sq, H, Dh), 0, 2, 1, 3)
        scores = torch.einsum("bhqd,bhkd->bhqk", q, k_cache) * (Dh ** -0.5)
        p = _softmax(scores, axis=-1)
        o = torch.einsum("bhqk,bhkd->bhqd", p, v_cache)
        return (lambda x, *d: x.permute(*d))(o, 0, 2, 1, 3).reshape(B, Sq, H * Dh) @ wo

    a = _A_ref(A_x, A_k_cache, A_v_cache, A_wq, A_wo)
    b = _B_ref(B_x, B_k_cache, B_v_cache, B_wq, B_wo)
    return torch.concatenate([a, b], axis=-1)
```

```asm
; @launch grid=(256,1,1) block=(384,1,1) lds=29696
.amdgcn_target "amdgcn-amd-amdhsa--gfx950"
.text
.globl concat_heads__sliding_block_cached__mha_block_cached__decode_kernel
.p2align 8
.type concat_heads__sliding_block_cached__mha_block_cached__decode_kernel,@function
concat_heads__sliding_block_cached__mha_block_cached__decode_kernel:
    s_cmp_ge_u32 s2, 256
    s_cbranch_scc1 L_end
    s_load_dwordx16 s[16:31], s[0:1], 0
    s_load_dwordx8 s[32:39], s[0:1], 64
    s_load_dwordx2 s[40:41], s[0:1], 96
    v_lshrrev_b32 v1, 6, v0
    v_and_b32 v0, 63, v0
    v_readfirstlane_b32 s3, v1
    v_lshrrev_b32 v2, 4, v0
    v_and_b32 v3, 15, v0
    v_and_b32 v6, 7, v0
    v_mov_b32 v1, 0
    s_lshr_b32 s4, s2, 3
    s_and_b32 s5, s2, 7
    s_lshr_b32 s9, s5, 1
    s_lshl_b32 s7, s9, 21
    s_lshl_b32 s8, s4, 8
    s_add_u32 s7, s7, s8
    s_lshl_b32 s8, s3, 6
    v_add_u32 v7, s8, v2
    v_lshlrev_b32 v8, 13, v7
    v_lshl_add_u32 v8, v3, 4, v8
    v_lshl_add_u32 v9, v3, 2, v7
    s_lshl_b32 s8, s9, 8
    v_add_lshl_u32 v9, v9, s8, 1
    s_mov_b32 s54, 0x1fe100
    s_mov_b32 s55, 0x20000
    s_mov_b32 s66, 2048
    s_mov_b32 s67, 0x20000
    s_mov_b32 s73, 0
    s_cmp_ge_u32 s3, 4
    s_cbranch_scc1 L_side
    s_waitcnt lgkmcnt(0)
    s_bitcmp1_b32 s5, 0
    s_cselect_b64 s[52:53], s[22:23], s[32:33]
    s_cselect_b64 s[64:65], s[16:17], s[26:27]
    s_add_u32 s52, s52, s7
    s_addc_u32 s53, s53, 0
    buffer_load_ushort v30, v9, s[64:67], 0 offen
    buffer_load_dwordx4 v[64:67], v8, s[52:55], s73 offen nt
    s_mov_b32 s73, 32768
    buffer_load_dwordx4 v[68:71], v8, s[52:55], s73 offen nt
    s_mov_b32 s73, 65536
    buffer_load_dwordx4 v[72:75], v8, s[52:55], s73 offen nt
    s_mov_b32 s73, 98304
    buffer_load_dwordx4 v[76:79], v8, s[52:55], s73 offen nt
    s_mov_b32 s73, 131072
    buffer_load_dwordx4 v[80:83], v8, s[52:55], s73 offen nt
    s_mov_b32 s73, 163840
    buffer_load_dwordx4 v[84:87], v8, s[52:55], s73 offen nt
    s_mov_b32 s73, 196608
    s_setprio 2
    s_mov_b32 s10, 0xcccccccc
    s_mov_b32 s11, 0xcccccccc
    s_mov_b32 s12, 0xaaaaaaaa
    s_mov_b32 s13, 0xaaaaaaaa
    s_mov_b32 s14, 0x3e0293ee
    s_mov_b32 s74, 0x05040100
    s_mov_b32 s75, 0x07060302
    v_lshlrev_b32 v4, 4, v0
    v_lshl_add_u32 v5, v3, 2, v2
    v_lshlrev_b32 v5, 4, v5
    v_mov_b32 v15, 0xffffff00
    s_lshl_b32 s7, s4, 23
    s_add_u32 s44, s28, s7
    s_addc_u32 s45, s29, 0
    s_mov_b32 s46, 8388608
    s_mov_b32 s47, 0x20000
    s_add_u32 s48, s30, s7
    s_addc_u32 s49, s31, 0
    s_mov_b32 s50, 8388608
    s_mov_b32 s51, 0x20000
    s_mov_b32 s60, s40
    s_mov_b32 s61, s41
    s_mov_b32 s62, 1835008
    s_mov_b32 s63, 0x20000
    s_mov_b32 s28, 0
    s_bfe_u32 s8, s5, 0x10000
    s_lshl_b32 s8, s8, 16
    s_xor_b32 s28, s28, s8
    s_bfe_u32 s8, s5, 0x10001
    s_lshl_b32 s8, s8, 21
    s_xor_b32 s28, s28, s8
    s_bfe_u32 s8, s5, 0x10002
    s_lshl_b32 s8, s8, 14
    s_xor_b32 s28, s28, s8
    s_mov_b32 s26, 0
    s_mov_b32 s27, s28
    s_mov_b32 s43, s28
    s_lshl_b32 s8, s3, 10
    v_add_u32 v10, s8, v4
    v_add_u32 v11, s8, v5
    v_mov_b32 v45, 1
    v_mov_b32 v16, 0
    v_mov_b32 v17, 0
    v_mov_b32 v18, 0
    v_mov_b32 v19, 0
    v_mov_b32 v20, 0
    v_mov_b32 v21, 0
    v_mov_b32 v22, 0
    v_mov_b32 v23, 0
    s_barrier
    s_waitcnt vmcnt(5)
    buffer_load_dwordx4 v[88:91], v8, s[52:55], s73 offen nt
    s_mov_b32 s73, 229376
    v_lshlrev_b32 v31, 16, v30
    v_dot2c_f32_bf16_dpp v16, v30, v64 row_newbcast:0 row_mask:0xf bank_mask:0xf
    s_nop 0
    v_dot2c_f32_bf16_dpp v17, v31, v64 row_newbcast:0 row_mask:0xf bank_mask:0xf
    v_dot2c_f32_bf16_dpp v18, v30, v65 row_newbcast:0 row_mask:0xf bank_mask:0xf
    v_dot2c_f32_bf16_dpp v19, v31, v65 row_newbcast:0 row_mask:0xf bank_mask:0xf
    v_dot2c_f32_bf16_dpp v20, v30, v66 row_newbcast:0 row_mask:0xf bank_mask:0xf
    v_dot2c_f32_bf16_dpp v21, v31, v66 row_newbcast:0 row_mask:0xf bank_mask:0xf
    v_dot2c_f32_bf16_dpp v22, v30, v67 row_newbcast:0 row_mask:0xf bank_mask:0xf
    v_dot2c_f32_bf16_dpp v23, v31, v67 row_newbcast:0 row_mask:0xf bank_mask:0xf
    s_waitcnt vmcnt(5)
    buffer_load_dwordx4 v[92:95], v8, s[52:55], s73 offen nt
    s_mov_b32 s73, 262144
    v_dot2c_f32_bf16_dpp v16, v30, v68 row_newbcast:1 row_mask:0xf bank_mask:0xf
    v_dot2c_f32_bf16_dpp v17, v31, v68 row_newbcast:1 row_mask:0xf bank_mask:0xf
    v_dot2c_f32_bf16_dpp v18, v30, v69 row_newbcast:1 row_mask:0xf bank_mask:0xf
    v_dot2c_f32_bf16_dpp v19, v31, v69 row_newbcast:1 row_mask:0xf bank_mask:0xf
    v_dot2c_f32_bf16_dpp v20, v30, v70 row_newbcast:1 row_mask:0xf bank_mask:0xf
    v_dot2c_f32_bf16_dpp v21, v31, v70 row_newbcast:1 row_mask:0xf bank_mask:0xf
    v_dot2c_f32_bf16_dpp v22, v30, v71 row_newbcast:1 row_mask:0xf bank_mask:0xf
    v_dot2c_f32_bf16_dpp v23, v31, v71 row_newbcast:1 row_mask:0xf bank_mask:0xf
    s_waitcnt vmcnt(5)
    buffer_load_dwordx4 v[96:99], v8, s[52:55], s73 offen nt
    s_mov_b32 s73, 294912
    v_dot2c_f32_bf16_dpp v16, v30, v72 row_newbcast:2 row_mask:0xf bank_mask:0xf
    v_dot2c_f32_bf16_dpp v17, v31, v72 row_newbcast:2 row_mask:0xf bank_mask:0xf
    v_dot2c_f32_bf16_dpp v18, v30, v73 row_newbcast:2 row_mask:0xf bank_mask:0xf
    v_dot2c_f32_bf16_dpp v19, v31, v73 row_newbcast:2 row_mask:0xf bank_mask:0xf
    v_dot2c_f32_bf16_dpp v20, v30, v74 row_newbcast:2 row_mask:0xf bank_mask:0xf
    v_dot2c_f32_bf16_dpp v21, v31, v74 row_newbcast:2 row_mask:0xf bank_mask:0xf
    v_dot2c_f32_bf16_dpp v22, v30, v75 row_newbcast:2 row_mask:0xf bank_mask:0xf
    v_dot2c_f32_bf16_dpp v23, v31, v75 row_newbcast:2 row_mask:0xf bank_mask:0xf
    s_waitcnt vmcnt(5)
    buffer_load_dwordx4 v[100:103], v8, s[52:55], s73 offen nt
    s_mov_b32 s73, 327680
    v_dot2c_f32_bf16_dpp v16, v30, v76 row_newbcast:3 row_mask:0xf bank_mask:0xf
    v_dot2c_f32_bf16_dpp v17, v31, v76 row_newbcast:3 row_mask:0xf bank_mask:0xf
    v_dot2c_f32_bf16_dpp v18, v30, v77 row_newbcast:3 row_mask:0xf bank_mask:0xf
    v_dot2c_f32_bf16_dpp v19, v31, v77 row_newbcast:3 row_mask:0xf bank_mask:0xf
    v_dot2c_f32_bf16_dpp v20, v30, v78 row_newbcast:3 row_mask:0xf bank_mask:0xf
    v_dot2c_f32_bf16_dpp v21, v31, v78 row_newbcast:3 row_mask:0xf bank_mask:0xf
    v_dot2c_f32_bf16_dpp v22, v30, v79 row_newbcast:3 row_mask:0xf bank_mask:0xf
    v_dot2c_f32_bf16_dpp v23, v31, v79 row_newbcast:3 row_mask:0xf bank_mask:0xf
    s_waitcnt vmcnt(5)
    buffer_load_dwordx4 v[104:107], v8, s[52:55], s73 offen nt
    s_mov_b32 s73, 360448
    v_dot2c_f32_bf16_dpp v16, v30, v80 row_newbcast:4 row_mask:0xf bank_mask:0xf
    v_dot2c_f32_bf16_dpp v17, v31, v80 row_newbcast:4 row_mask:0xf bank_mask:0xf
    v_dot2c_f32_bf16_dpp v18, v30, v81 row_newbcast:4 row_mask:0xf bank_mask:0xf
    v_dot2c_f32_bf16_dpp v19, v31, v81 row_newbcast:4 row_mask:0xf bank_mask:0xf
    v_dot2c_f32_bf16_dpp v20, v30, v82 row_newbcast:4 row_mask:0xf bank_mask:0xf
    v_dot2c_f32_bf16_dpp v21, v31, v82 row_newbcast:4 row_mask:0xf bank_mask:0xf
    v_dot2c_f32_bf16_dpp v22, v30, v83 row_newbcast:4 row_mask:0xf bank_mask:0xf
    v_dot2c_f32_bf16_dpp v23, v31, v83 row_newbcast:4 row_mask:0xf bank_mask:0xf
    s_waitcnt vmcnt(5)
    buffer_load_dwordx4 v[108:111], v8, s[52:55], s73 offen nt
    s_mov_b32 s73, 393216
    v_dot2c_f32_bf16_dpp v16, v30, v84 row_newbcast:5 row_mask:0xf bank_mask:0xf
    v_dot2c_f32_bf16_dpp v17, v31, v84 row_newbcast:5 row_mask:0xf bank_mask:0xf
    v_dot2c_f32_bf16_dpp v18, v30, v85 row_newbcast:5 row_mask:0xf bank_mask:0xf
    v_dot2c_f32_bf16_dpp v19, v31, v85 row_newbcast:5 row_mask:0xf bank_mask:0xf
    v_dot2c_f32_bf16_dpp v20, v30, v86 row_newbcast:5 row_mask:0xf bank_mask:0xf
    v_dot2c_f32_bf16_dpp v21, v31, v86 row_newbcast:5 row_mask:0xf bank_mask:0xf
    v_dot2c_f32_bf16_dpp v22, v30, v87 row_newbcast:5 row_mask:0xf bank_mask:0xf
    v_dot2c_f32_bf16_dpp v23, v31, v87 row_newbcast:5 row_mask:0xf bank_mask:0xf
    s_waitcnt vmcnt(5)
    buffer_load_dwordx4 v[112:115], v8, s[52:55], s73 offen nt
    s_mov_b32 s73, 425984
    v_dot2c_f32_bf16_dpp v16, v30, v88 row_newbcast:6 row_mask:0xf bank_mask:0xf
    v_dot2c_f32_bf16_dpp v17, v31, v88 row_newbcast:6 row_mask:0xf bank_mask:0xf
    v_dot2c_f32_bf16_dpp v18, v30, v89 row_newbcast:6 row_mask:0xf bank_mask:0xf
    v_dot2c_f32_bf16_dpp v19, v31, v89 row_newbcast:6 row_mask:0xf bank_mask:0xf
    v_dot2c_f32_bf16_dpp v20, v30, v90 row_newbcast:6 row_mask:0xf bank_mask:0xf
    v_dot2c_f32_bf16_dpp v21, v31, v90 row_newbcast:6 row_mask:0xf bank_mask:0xf
    v_dot2c_f32_bf16_dpp v22, v30, v91 row_newbcast:6 row_mask:0xf bank_mask:0xf
    v_dot2c_f32_bf16_dpp v23, v31, v91 row_newbcast:6 row_mask:0xf bank_mask:0xf
    s_waitcnt vmcnt(5)
    buffer_load_dwordx4 v[116:119], v8, s[52:55], s73 offen nt
    s_mov_b32 s73, 458752
    v_dot2c_f32_bf16_dpp v16, v30, v92 row_newbcast:7 row_mask:0xf bank_mask:0xf
    v_dot2c_f32_bf16_dpp v17, v31, v92 row_newbcast:7 row_mask:0xf bank_mask:0xf
    v_dot2c_f32_bf16_dpp v18, v30, v93 row_newbcast:7 row_mask:0xf bank_mask:0xf
    v_dot2c_f32_bf16_dpp v19, v31, v93 row_newbcast:7 row_mask:0xf bank_mask:0xf
    v_dot2c_f32_bf16_dpp v20, v30, v94 row_newbcast:7 row_mask:0xf bank_mask:0xf
    v_dot2c_f32_bf16_dpp v21, v31, v94 row_newbcast:7 row_mask:0xf bank_mask:0xf
    v_dot2c_f32_bf16_dpp v22, v30, v95 row_newbcast:7 row_mask:0xf bank_mask:0xf
    v_dot2c_f32_bf16_dpp v23, v31, v95 row_newbcast:7 row_mask:0xf bank_mask:0xf
    s_waitcnt vmcnt(5)
    buffer_load_dwordx4 v[120:123], v8, s[52:55], s73 offen nt
    s_mov_b32 s73, 491520
    v_dot2c_f32_bf16_dpp v16, v30, v96 row_newbcast:8 row_mask:0xf bank_mask:0xf
    v_dot2c_f32_bf16_dpp v17, v31, v96 row_newbcast:8 row_mask:0xf bank_mask:0xf
    v_dot2c_f32_bf16_dpp v18, v30, v97 row_newbcast:8 row_mask:0xf bank_mask:0xf
    v_dot2c_f32_bf16_dpp v19, v31, v97 row_newbcast:8 row_mask:0xf bank_mask:0xf
    v_dot2c_f32_bf16_dpp v20, v30, v98 row_newbcast:8 row_mask:0xf bank_mask:0xf
    v_dot2c_f32_bf16_dpp v21, v31, v98 row_newbcast:8 row_mask:0xf bank_mask:0xf
    v_dot2c_f32_bf16_dpp v22, v30, v99 row_newbcast:8 row_mask:0xf bank_mask:0xf
    v_dot2c_f32_bf16_dpp v23, v31, v99 row_newbcast:8 row_mask:0xf bank_mask:0xf
    s_waitcnt vmcnt(5)
    buffer_load_dwordx4 v[124:127], v8, s[52:55], s73 offen nt
    s_mov_b32 s73, 0
    v_dot2c_f32_bf16_dpp v16, v30, v100 row_newbcast:9 row_mask:0xf bank_mask:0xf
    v_dot2c_f32_bf16_dpp v17, v31, v100 row_newbcast:9 row_mask:0xf bank_mask:0xf
    v_dot2c_f32_bf16_dpp v18, v30, v101 row_newbcast:9 row_mask:0xf bank_mask:0xf
    v_dot2c_f32_bf16_dpp v19, v31, v101 row_newbcast:9 row_mask:0xf bank_mask:0xf
    v_dot2c_f32_bf16_dpp v20, v30, v102 row_newbcast:9 row_mask:0xf bank_mask:0xf
    v_dot2c_f32_bf16_dpp v21, v31, v102 row_newbcast:9 row_mask:0xf bank_mask:0xf
    v_dot2c_f32_bf16_dpp v22, v30, v103 row_newbcast:9 row_mask:0xf bank_mask:0xf
    v_dot2c_f32_bf16_dpp v23, v31, v103 row_newbcast:9 row_mask:0xf bank_mask:0xf
    s_waitcnt vmcnt(5)
    buffer_load_dwordx4 v[128:131], v10, s[44:47], s43 offen nt
    s_xor_b32 s43, s27, 4096
    v_dot2c_f32_bf16_dpp v16, v30, v104 row_newbcast:10 row_mask:0xf bank_mask:0xf
    v_dot2c_f32_bf16_dpp v17, v31, v104 row_newbcast:10 row_mask:0xf bank_mask:0xf
    v_dot2c_f32_bf16_dpp v18, v30, v105 row_newbcast:10 row_mask:0xf bank_mask:0xf
    v_dot2c_f32_bf16_dpp v19, v31, v105 row_newbcast:10 row_mask:0xf bank_mask:0xf
    v_dot2c_f32_bf16_dpp v20, v30, v106 row_newbcast:10 row_mask:0xf bank_mask:0xf
    v_dot2c_f32_bf16_dpp v21, v31, v106 row_newbcast:10 row_mask:0xf bank_mask:0xf
    v_dot2c_f32_bf16_dpp v22, v30, v107 row_newbcast:10 row_mask:0xf bank_mask:0xf
    v_dot2c_f32_bf16_dpp v23, v31, v107 row_newbcast:10 row_mask:0xf bank_mask:0xf
    s_waitcnt vmcnt(5)
    buffer_load_dwordx4 v[132:135], v10, s[44:47], s43 offen nt
    s_xor_b32 s43, s27, 8192
    v_dot2c_f32_bf16_dpp v16, v30, v108 row_newbcast:11 row_mask:0xf bank_mask:0xf
    v_dot2c_f32_bf16_dpp v17, v31, v108 row_newbcast:11 row_mask:0xf bank_mask:0xf
    v_dot2c_f32_bf16_dpp v18, v30, v109 row_newbcast:11 row_mask:0xf bank_mask:0xf
    v_dot2c_f32_bf16_dpp v19, v31, v109 row_newbcast:11 row_mask:0xf bank_mask:0xf
    v_dot2c_f32_bf16_dpp v20, v30, v110 row_newbcast:11 row_mask:0xf bank_mask:0xf
    v_dot2c_f32_bf16_dpp v21, v31, v110 row_newbcast:11 row_mask:0xf bank_mask:0xf
    v_dot2c_f32_bf16_dpp v22, v30, v111 row_newbcast:11 row_mask:0xf bank_mask:0xf
    v_dot2c_f32_bf16_dpp v23, v31, v111 row_newbcast:11 row_mask:0xf bank_mask:0xf
    s_waitcnt vmcnt(5)
    buffer_load_dwordx4 v[136:139], v10, s[44:47], s43 offen nt
    s_xor_b32 s43, s27, 12288
    v_dot2c_f32_bf16_dpp v16, v30, v112 row_newbcast:12 row_mask:0xf bank_mask:0xf
    v_dot2c_f32_bf16_dpp v17, v31, v112 row_newbcast:12 row_mask:0xf bank_mask:0xf
    v_dot2c_f32_bf16_dpp v18, v30, v113 row_newbcast:12 row_mask:0xf bank_mask:0xf
    v_dot2c_f32_bf16_dpp v19, v31, v113 row_newbcast:12 row_mask:0xf bank_mask:0xf
    v_dot2c_f32_bf16_dpp v20, v30, v114 row_newbcast:12 row_mask:0xf bank_mask:0xf
    v_dot2c_f32_bf16_dpp v21, v31, v114 row_newbcast:12 row_mask:0xf bank_mask:0xf
    v_dot2c_f32_bf16_dpp v22, v30, v115 row_newbcast:12 row_mask:0xf bank_mask:0xf
    v_dot2c_f32_bf16_dpp v23, v31, v115 row_newbcast:12 row_mask:0xf bank_mask:0xf
    s_waitcnt vmcnt(5)
    buffer_load_dwordx4 v[140:143], v10, s[44:47], s43 offen nt
    s_xor_b32 s43, s27, 49152
    v_dot2c_f32_bf16_dpp v16, v30, v116 row_newbcast:13 row_mask:0xf bank_mask:0xf
    v_dot2c_f32_bf16_dpp v17, v31, v116 row_newbcast:13 row_mask:0xf bank_mask:0xf
    v_dot2c_f32_bf16_dpp v18, v30, v117 row_newbcast:13 row_mask:0xf bank_mask:0xf
    v_dot2c_f32_bf16_dpp v19, v31, v117 row_newbcast:13 row_mask:0xf bank_mask:0xf
    v_dot2c_f32_bf16_dpp v20, v30, v118 row_newbcast:13 row_mask:0xf bank_mask:0xf
    v_dot2c_f32_bf16_dpp v21, v31, v118 row_newbcast:13 row_mask:0xf bank_mask:0xf
    v_dot2c_f32_bf16_dpp v22, v30, v119 row_newbcast:13 row_mask:0xf bank_mask:0xf
    v_dot2c_f32_bf16_dpp v23, v31, v119 row_newbcast:13 row_mask:0xf bank_mask:0xf
    s_waitcnt vmcnt(5)
    buffer_load_dwordx4 v[144:147], v10, s[44:47], s43 offen nt
    s_xor_b32 s43, s27, 53248
    v_dot2c_f32_bf16_dpp v16, v30, v120 row_newbcast:14 row_mask:0xf bank_mask:0xf
    v_dot2c_f32_bf16_dpp v17, v31, v120 row_newbcast:14 row_mask:0xf bank_mask:0xf
    v_dot2c_f32_bf16_dpp v18, v30, v121 row_newbcast:14 row_mask:0xf bank_mask:0xf
    v_dot2c_f32_bf16_dpp v19, v31, v121 row_newbcast:14 row_mask:0xf bank_mask:0xf
    v_dot2c_f32_bf16_dpp v20, v30, v122 row_newbcast:14 row_mask:0xf bank_mask:0xf
    v_dot2c_f32_bf16_dpp v21, v31, v122 row_newbcast:14 row_mask:0xf bank_mask:0xf
    v_dot2c_f32_bf16_dpp v22, v30, v123 row_newbcast:14 row_mask:0xf bank_mask:0xf
    v_dot2c_f32_bf16_dpp v23, v31, v123 row_newbcast:14 row_mask:0xf bank_mask:0xf
    s_waitcnt vmcnt(5)
    buffer_load_dwordx4 v[148:151], v10, s[44:47], s43 offen nt
    s_xor_b32 s43, s27, 57344
    v_dot2c_f32_bf16_dpp v16, v30, v124 row_newbcast:15 row_mask:0xf bank_mask:0xf
    v_dot2c_f32_bf16_dpp v17, v31, v124 row_newbcast:15 row_mask:0xf bank_mask:0xf
    v_dot2c_f32_bf16_dpp v18, v30, v125 row_newbcast:15 row_mask:0xf bank_mask:0xf
    v_dot2c_f32_bf16_dpp v19, v31, v125 row_newbcast:15 row_mask:0xf bank_mask:0xf
    v_dot2c_f32_bf16_dpp v20, v30, v126 row_newbcast:15 row_mask:0xf bank_mask:0xf
    v_dot2c_f32_bf16_dpp v21, v31, v126 row_newbcast:15 row_mask:0xf bank_mask:0xf
    v_dot2c_f32_bf16_dpp v22, v30, v127 row_newbcast:15 row_mask:0xf bank_mask:0xf
    v_dot2c_f32_bf16_dpp v23, v31, v127 row_newbcast:15 row_mask:0xf bank_mask:0xf
    v_permlane32_swap_b32 v16, v20
    v_permlane32_swap_b32 v17, v21
    v_permlane32_swap_b32 v18, v22
    v_permlane32_swap_b32 v19, v23
    v_add_f32 v16, v16, v20
    v_add_f32 v17, v17, v21
    v_add_f32 v18, v18, v22
    v_add_f32 v19, v19, v23
    s_nop 0
    v_permlane16_swap_b32 v16, v18
    v_permlane16_swap_b32 v17, v19
    v_add_f32 v16, v16, v18
    v_add_f32 v17, v17, v19
    v_lshrrev_b32 v12, 1, v11
    ds_write_b64 v12, v[16:17] offset:0
    s_mov_b64 exec, 1
    ds_add_u32 v1, v45 offset:4660
    s_mov_b64 exec, -1
    s_waitcnt vmcnt(5)
    buffer_load_dwordx4 v[152:155], v10, s[44:47], s43 offen nt
    s_xor_b32 s43, s27, 61440
    s_waitcnt vmcnt(5)
    buffer_load_dwordx4 v[156:159], v10, s[44:47], s43 offen nt
    s_xor_b32 s43, s27, 196608
    s_waitcnt vmcnt(5)
    buffer_load_dwordx4 v[160:163], v10, s[44:47], s43 offen nt
    s_xor_b32 s43, s27, 200704
    s_waitcnt vmcnt(5)
    buffer_load_dwordx4 v[164:167], v10, s[44:47], s43 offen nt
    s_xor_b32 s43, s27, 204800
    s_waitcnt vmcnt(5)
    buffer_load_dwordx4 v[168:171], v10, s[44:47], s43 offen nt
    s_xor_b32 s43, s27, 208896
    s_waitcnt vmcnt(5)
    buffer_load_dwordx4 v[172:175], v10, s[44:47], s43 offen nt
    s_xor_b32 s43, s27, 245760
    s_waitcnt vmcnt(5)
    buffer_load_dwordx4 v[176:179], v10, s[44:47], s43 offen nt
    s_xor_b32 s43, s27, 249856
    s_waitcnt vmcnt(5)
    buffer_load_dwordx4 v[180:183], v10, s[44:47], s43 offen nt
    s_xor_b32 s43, s27, 253952
    s_waitcnt vmcnt(5)
    buffer_load_dwordx4 v[184:187], v10, s[44:47], s43 offen nt
    s_xor_b32 s43, s27, 258048
    s_waitcnt vmcnt(5)
    buffer_load_dwordx4 v[188:191], v10, s[44:47], s43 offen nt
    s_xor_b32 s43, s27, 262144
    s_waitcnt vmcnt(5)
    buffer_load_dwordx4 v[192:195], v10, s[44:47], s43 offen nt
    s_xor_b32 s43, s27, 266240
    s_waitcnt vmcnt(5)
    buffer_load_dwordx4 v[196:199], v10, s[44:47], s43 offen nt
    s_xor_b32 s43, s27, 270336
    s_waitcnt vmcnt(5)
    buffer_load_dwordx4 v[200:203], v10, s[44:47], s43 offen nt
    s_xor_b32 s43, s27, 274432
    s_waitcnt vmcnt(5)
    buffer_load_dwordx4 v[204:207], v10, s[44:47], s43 offen nt
    s_xor_b32 s43, s27, 311296
    s_waitcnt vmcnt(5)
    buffer_load_dwordx4 v[208:211], v10, s[44:47], s43 offen nt
    s_xor_b32 s43, s27, 315392
    s_waitcnt vmcnt(5)
    buffer_load_dwordx4 v[212:215], v10, s[44:47], s43 offen nt
    s_xor_b32 s43, s27, 319488
    s_waitcnt vmcnt(5)
    buffer_load_dwordx4 v[216:219], v10, s[44:47], s43 offen nt
    s_xor_b32 s43, s27, 323584
    s_waitcnt vmcnt(5)
    buffer_load_dwordx4 v[220:223], v10, s[44:47], s43 offen nt
    s_xor_b32 s43, s27, 458752
    s_waitcnt vmcnt(5)
    buffer_load_dwordx4 v[224:227], v10, s[44:47], s43 offen nt
    s_xor_b32 s43, s27, 462848
    s_waitcnt vmcnt(5)
    buffer_load_dwordx4 v[228:231], v10, s[44:47], s43 offen nt
    s_xor_b32 s43, s27, 466944
    s_waitcnt vmcnt(5)
    buffer_load_dwordx4 v[232:235], v10, s[44:47], s43 offen nt
    s_xor_b32 s43, s27, 471040
    s_waitcnt vmcnt(5)
    buffer_load_dwordx4 v[236:239], v10, s[44:47], s43 offen nt
    s_xor_b32 s43, s27, 507904
    s_waitcnt vmcnt(5)
    buffer_load_dwordx4 v[240:243], v10, s[44:47], s43 offen nt
    s_xor_b32 s43, s27, 512000
    s_waitcnt vmcnt(5)
    buffer_load_dwordx4 v[244:247], v10, s[44:47], s43 offen nt
    s_xor_b32 s43, s27, 516096
    s_waitcnt vmcnt(5)
    buffer_load_dwordx4 v[248:251], v10, s[44:47], s43 offen nt
    s_xor_b32 s43, s27, 520192
    s_waitcnt vmcnt(5)
    buffer_load_dwordx4 v[252:255], v10, s[44:47], s43 offen nt
    s_add_u32 s26, s26, 1
    s_mov_b32 s27, s28
    s_bfe_u32 s8, s26, 0x10000
    s_lshl_b32 s8, s8, 19
    s_or_b32 s27, s27, s8
    s_bfe_u32 s8, s26, 0x10001
    s_lshl_b32 s8, s8, 20
    s_or_b32 s27, s27, s8
    s_bfe_u32 s8, s26, 0x10002
    s_lshl_b32 s8, s8, 22
    s_or_b32 s27, s27, s8
    s_xor_b32 s43, s27, 0
    s_mov_b32 s76, 2000000
L_lw0:
    ds_read_b32 v42, v1 offset:4668
    s_waitcnt lgkmcnt(0)
    v_readfirstlane_b32 s8, v42
    s_nop 0
    s_cmp_ge_u32 s8, 1
    s_cbranch_scc1 L_lwd0
    s_sub_u32 s76, s76, 1
    s_cbranch_scc1 L_lwd0
    s_sleep 1
    s_branch L_lw0
L_lwd0:
    s_and_b32 s6, s8, 0xff
    v_lshlrev_b32 v12, 4, v3
    ds_read_b128 v[24:27], v12 offset:4096
    v_lshlrev_b32 v12, 2, v0
    s_lshl_b32 s8, s3, 12
    v_add_u32 v12, s8, v12
    v_mov_b32 v13, v12
    s_mov_b32 s72, -4
    s_lshl_b32 s8, s3, 2
    v_mov_b32 v9, s8
    v_mov_b32 v14, s8
    v_mov_b32 v28, 0xff800000
    s_mov_b32 s15, 7
    s_waitcnt lgkmcnt(0)
L_k:
    s_memrealtime s[78:79]
    ds_read_b32 v47, v9 offset:4688
    v_dot2_f32_bf16 v32, v128, v24, 0
    v_dot2_f32_bf16 v32, v129, v25, v32
    v_dot2_f32_bf16 v32, v130, v26, v32
    v_dot2_f32_bf16 v32, v131, v27, v32
    s_waitcnt vmcnt(7)
    s_cmp_lt_i32 s72, -32
    s_cbranch_scc1 L_f1
    s_waitcnt vmcnt(5)
    s_cmp_lt_i32 s72, 0
    s_cbranch_scc1 L_f1
    s_waitcnt vmcnt(4)
    s_cmp_le_i32 s72, 0
    s_cbranch_scc1 L_f1
    s_waitcnt vmcnt(3)
L_f1:
    buffer_load_dwordx4 v[128:131], v10, s[44:47], s43 offen nt
    s_xor_b32 s43, s27, 4096
    s_waitcnt lgkmcnt(0)
    v_readfirstlane_b32 s72, v47
    v_mov_b32 v44, s78
    s_mov_b64 exec, 1
    ds_write_b32 v14, v44 offset:4704
    ds_add_u32 v1, v45 offset:4656
    s_mov_b64 exec, -1
    v_add_u32 v14, 16, v14
    v_dot2_f32_bf16 v33, v132, v24, 0
    v_dot2_f32_bf16 v33, v133, v25, v33
    v_dot2_f32_bf16 v33, v134, v26, v33
    v_dot2_f32_bf16 v33, v135, v27, v33
    s_waitcnt vmcnt(7)
    s_cmp_lt_i32 s72, -48
    s_cbranch_scc1 L_f2
    s_waitcnt vmcnt(5)
    s_cmp_lt_i32 s72, -16
    s_cbranch_scc1 L_f2
    s_waitcnt vmcnt(4)
    s_cmp_le_i32 s72, 16
    s_cbranch_scc1 L_f2
    s_waitcnt vmcnt(3)
L_f2:
    buffer_load_dwordx4 v[132:135], v10, s[44:47], s43 offen nt
    s_xor_b32 s43, s27, 8192
    v_add_f32_dpp v34, v32, v32 row_ror:8 row_mask:0xf bank_mask:0x3
    v_add_f32_dpp v34, v33, v33 row_ror:8 row_mask:0xf bank_mask:0xc
    v_dot2_f32_bf16 v32, v136, v24, 0
    v_dot2_f32_bf16 v32, v137, v25, v32
    v_dot2_f32_bf16 v32, v138, v26, v32
    v_dot2_f32_bf16 v32, v139, v27, v32
    s_waitcnt vmcnt(7)
    s_cmp_lt_i32 s72, -40
    s_cbranch_scc1 L_f3
    s_waitcnt vmcnt(5)
    s_cmp_lt_i32 s72, -8
    s_cbranch_scc1 L_f3
    s_waitcnt vmcnt(4)
    s_cmp_le_i32 s72, 8
    s_cbranch_scc1 L_f3
    s_waitcnt vmcnt(3)
L_f3:
    buffer_load_dwordx4 v[136:139], v10, s[44:47], s43 offen nt
    s_xor_b32 s43, s27, 12288
    v_dot2_f32_bf16 v33, v140, v24, 0
    v_dot2_f32_bf16 v33, v141, v25, v33
    v_dot2_f32_bf16 v33, v142, v26, v33
    v_dot2_f32_bf16 v33, v143, v27, v33
    s_waitcnt vmcnt(7)
    s_cmp_lt_i32 s72, -56
    s_cbranch_scc1 L_f4
    s_waitcnt vmcnt(5)
    s_cmp_lt_i32 s72, -24
    s_cbranch_scc1 L_f4
    s_waitcnt vmcnt(4)
    s_cmp_le_i32 s72, 24
    s_cbranch_scc1 L_f4
    s_waitcnt vmcnt(3)
L_f4:
    buffer_load_dwordx4 v[140:143], v10, s[44:47], s43 offen nt
    s_xor_b32 s43, s27, 49152
    v_add_f32_dpp v35, v32, v32 row_ror:8 row_mask:0xf bank_mask:0x3
    v_add_f32_dpp v35, v33, v33 row_ror:8 row_mask:0xf bank_mask:0xc
    v_add_f32_dpp v36, v34, v34 row_shl:4 row_mask:0xf bank_mask:0x5
    s_nop 0
    v_add_f32_dpp v36, v35, v35 row_shr:4 row_mask:0xf bank_mask:0xa
    v_dot2_f32_bf16 v32, v144, v24, 0
    v_dot2_f32_bf16 v32, v145, v25, v32
    v_dot2_f32_bf16 v32, v146, v26, v32
    v_dot2_f32_bf16 v32, v147, v27, v32
    s_waitcnt vmcnt(7)
    s_cmp_lt_i32 s72, -36
    s_cbranch_scc1 L_f5
    s_waitcnt vmcnt(5)
    s_cmp_lt_i32 s72, -4
    s_cbranch_scc1 L_f5
    s_waitcnt vmcnt(4)
    s_cmp_le_i32 s72, 4
    s_cbranch_scc1 L_f5
    s_waitcnt vmcnt(3)
L_f5:
    buffer_load_dwordx4 v[144:147], v10, s[44:47], s43 offen nt
    s_xor_b32 s43, s27, 53248
    v_dot2_f32_bf16 v33, v148, v24, 0
    v_dot2_f32_bf16 v33, v149, v25, v33
    v_dot2_f32_bf16 v33, v150, v26, v33
    v_dot2_f32_bf16 v33, v151, v27, v33
    s_waitcnt vmcnt(7)
    s_cmp_lt_i32 s72, -52
    s_cbranch_scc1 L_f6
    s_waitcnt vmcnt(5)
    s_cmp_lt_i32 s72, -20
    s_cbranch_scc1 L_f6
    s_waitcnt vmcnt(4)
    s_cmp_le_i32 s72, 20
    s_cbranch_scc1 L_f6
    s_waitcnt vmcnt(3)
L_f6:
    buffer_load_dwordx4 v[148:151], v10, s[44:47], s43 offen nt
    s_xor_b32 s43, s27, 57344
    v_add_f32_dpp v34, v32, v32 row_ror:8 row_mask:0xf bank_mask:0x3
    v_add_f32_dpp v34, v33, v33 row_ror:8 row_mask:0xf bank_mask:0xc
    v_dot2_f32_bf16 v32, v152, v24, 0
    v_dot2_f32_bf16 v32, v153, v25, v32
    v_dot2_f32_bf16 v32, v154, v26, v32
    v_dot2_f32_bf16 v32, v155, v27, v32
    s_waitcnt vmcnt(7)
    s_cmp_lt_i32 s72, -44
    s_cbranch_scc1 L_f7
    s_waitcnt vmcnt(5)
    s_cmp_lt_i32 s72, -12
    s_cbranch_scc1 L_f7
    s_waitcnt vmcnt(4)
    s_cmp_le_i32 s72, 12
    s_cbranch_scc1 L_f7
    s_waitcnt vmcnt(3)
L_f7:
    buffer_load_dwordx4 v[152:155], v10, s[44:47], s43 offen nt
    s_xor_b32 s43, s27, 61440
    v_dot2_f32_bf16 v33, v156, v24, 0
    v_dot2_f32_bf16 v33, v157, v25, v33
    v_dot2_f32_bf16 v33, v158, v26, v33
    v_dot2_f32_bf16 v33, v159, v27, v33
    s_waitcnt vmcnt(7)
    s_cmp_lt_i32 s72, -60
    s_cbranch_scc1 L_f8
    s_waitcnt vmcnt(5)
    s_cmp_lt_i32 s72, -28
    s_cbranch_scc1 L_f8
    s_waitcnt vmcnt(4)
    s_cmp_le_i32 s72, 28
    s_cbranch_scc1 L_f8
    s_waitcnt vmcnt(3)
L_f8:
    buffer_load_dwordx4 v[156:159], v10, s[44:47], s43 offen nt
    s_xor_b32 s43, s27, 196608
    v_add_f32_dpp v35, v32, v32 row_ror:8 row_mask:0xf bank_mask:0x3
    v_add_f32_dpp v35, v33, v33 row_ror:8 row_mask:0xf bank_mask:0xc
    v_add_f32_dpp v37, v34, v34 row_shl:4 row_mask:0xf bank_mask:0x5
    s_nop 0
    v_add_f32_dpp v37, v35, v35 row_shr:4 row_mask:0xf bank_mask:0xa
    v_add_f32_dpp v40, v36, v36 quad_perm:[2,3,0,1] row_mask:0xf bank_mask:0xf
    s_nop 0
    v_add_f32_dpp v41, v37, v37 quad_perm:[2,3,0,1] row_mask:0xf bank_mask:0xf
    v_cndmask_b32 v38, v40, v41, s[10:11]
    ds_read_b32 v47, v9 offset:4688
    v_dot2_f32_bf16 v32, v160, v24, 0
    v_dot2_f32_bf16 v32, v161, v25, v32
    v_dot2_f32_bf16 v32, v162, v26, v32
    v_dot2_f32_bf16 v32, v163, v27, v32
    s_waitcnt vmcnt(7)
    s_cmp_lt_i32 s72, -34
    s_cbranch_scc1 L_f9
    s_waitcnt vmcnt(5)
    s_cmp_lt_i32 s72, -2
    s_cbranch_scc1 L_f9
    s_waitcnt vmcnt(4)
    s_cmp_le_i32 s72, 2
    s_cbranch_scc1 L_f9
    s_waitcnt vmcnt(3)
L_f9:
    buffer_load_dwordx4 v[160:163], v10, s[44:47], s43 offen nt
    s_xor_b32 s43, s27, 200704
    s_waitcnt lgkmcnt(0)
    v_readfirstlane_b32 s72, v47
    v_dot2_f32_bf16 v33, v164, v24, 0
    v_dot2_f32_bf16 v33, v165, v25, v33
    v_dot2_f32_bf16 v33, v166, v26, v33
    v_dot2_f32_bf16 v33, v167, v27, v33
    s_waitcnt vmcnt(7)
    s_cmp_lt_i32 s72, -50
    s_cbranch_scc1 L_f10
    s_waitcnt vmcnt(5)
    s_cmp_lt_i32 s72, -18
    s_cbranch_scc1 L_f10
    s_waitcnt vmcnt(4)
    s_cmp_le_i32 s72, 18
    s_cbranch_scc1 L_f10
    s_waitcnt vmcnt(3)
L_f10:
    buffer_load_dwordx4 v[164:167], v10, s[44:47], s43 offen nt
    s_xor_b32 s43, s27, 204800
    v_add_f32_dpp v34, v32, v32 row_ror:8 row_mask:0xf bank_mask:0x3
    v_add_f32_dpp v34, v33, v33 row_ror:8 row_mask:0xf bank_mask:0xc
    v_dot2_f32_bf16 v32, v168, v24, 0
    v_dot2_f32_bf16 v32, v169, v25, v32
    v_dot2_f32_bf16 v32, v170, v26, v32
    v_dot2_f32_bf16 v32, v171, v27, v32
    s_waitcnt vmcnt(7)
    s_cmp_lt_i32 s72, -42
    s_cbranch_scc1 L_f11
    s_waitcnt vmcnt(5)
    s_cmp_lt_i32 s72, -10
    s_cbranch_scc1 L_f11
    s_waitcnt vmcnt(4)
    s_cmp_le_i32 s72, 10
    s_cbranch_scc1 L_f11
    s_waitcnt vmcnt(3)
L_f11:
    buffer_load_dwordx4 v[168:171], v10, s[44:47], s43 offen nt
    s_xor_b32 s43, s27, 208896
    v_dot2_f32_bf16 v33, v172, v24, 0
    v_dot2_f32_bf16 v33, v173, v25, v33
    v_dot2_f32_bf16 v33, v174, v26, v33
    v_dot2_f32_bf16 v33, v175, v27, v33
    s_waitcnt vmcnt(7)
    s_cmp_lt_i32 s72, -58
    s_cbranch_scc1 L_f12
    s_waitcnt vmcnt(5)
    s_cmp_lt_i32 s72, -26
    s_cbranch_scc1 L_f12
    s_waitcnt vmcnt(4)
    s_cmp_le_i32 s72, 26
    s_cbranch_scc1 L_f12
    s_waitcnt vmcnt(3)
L_f12:
    buffer_load_dwordx4 v[172:175], v10, s[44:47], s43 offen nt
    s_xor_b32 s43, s27, 245760
    v_add_f32_dpp v35, v32, v32 row_ror:8 row_mask:0xf bank_mask:0x3
    v_add_f32_dpp v35, v33, v33 row_ror:8 row_mask:0xf bank_mask:0xc
    v_add_f32_dpp v36, v34, v34 row_shl:4 row_mask:0xf bank_mask:0x5
    s_nop 0
    v_add_f32_dpp v36, v35, v35 row_shr:4 row_mask:0xf bank_mask:0xa
    v_dot2_f32_bf16 v32, v176, v24, 0
    v_dot2_f32_bf16 v32, v177, v25, v32
    v_dot2_f32_bf16 v32, v178, v26, v32
    v_dot2_f32_bf16 v32, v179, v27, v32
    s_waitcnt vmcnt(7)
    s_cmp_lt_i32 s72, -38
    s_cbranch_scc1 L_f13
    s_waitcnt vmcnt(5)
    s_cmp_lt_i32 s72, -6
    s_cbranch_scc1 L_f13
    s_waitcnt vmcnt(4)
    s_cmp_le_i32 s72, 6
    s_cbranch_scc1 L_f13
    s_waitcnt vmcnt(3)
L_f13:
    buffer_load_dwordx4 v[176:179], v10, s[44:47], s43 offen nt
    s_xor_b32 s43, s27, 249856
    v_dot2_f32_bf16 v33, v180, v24, 0
    v_dot2_f32_bf16 v33, v181, v25, v33
    v_dot2_f32_bf16 v33, v182, v26, v33
    v_dot2_f32_bf16 v33, v183, v27, v33
    s_waitcnt vmcnt(7)
    s_cmp_lt_i32 s72, -54
    s_cbranch_scc1 L_f14
    s_waitcnt vmcnt(5)
    s_cmp_lt_i32 s72, -22
    s_cbranch_scc1 L_f14
    s_waitcnt vmcnt(4)
    s_cmp_le_i32 s72, 22
    s_cbranch_scc1 L_f14
    s_waitcnt vmcnt(3)
L_f14:
    buffer_load_dwordx4 v[180:183], v10, s[44:47], s43 offen nt
    s_xor_b32 s43, s27, 253952
    v_add_f32_dpp v34, v32, v32 row_ror:8 row_mask:0xf bank_mask:0x3
    v_add_f32_dpp v34, v33, v33 row_ror:8 row_mask:0xf bank_mask:0xc
    v_dot2_f32_bf16 v32, v184, v24, 0
    v_dot2_f32_bf16 v32, v185, v25, v32
    v_dot2_f32_bf16 v32, v186, v26, v32
    v_dot2_f32_bf16 v32, v187, v27, v32
    s_waitcnt vmcnt(7)
    s_cmp_lt_i32 s72, -46
    s_cbranch_scc1 L_f15
    s_waitcnt vmcnt(5)
    s_cmp_lt_i32 s72, -14
    s_cbranch_scc1 L_f15
    s_waitcnt vmcnt(4)
    s_cmp_le_i32 s72, 14
    s_cbranch_scc1 L_f15
    s_waitcnt vmcnt(3)
L_f15:
    buffer_load_dwordx4 v[184:187], v10, s[44:47], s43 offen nt
    s_xor_b32 s43, s27, 258048
    v_dot2_f32_bf16 v33, v188, v24, 0
    v_dot2_f32_bf16 v33, v189, v25, v33
    v_dot2_f32_bf16 v33, v190, v26, v33
    v_dot2_f32_bf16 v33, v191, v27, v33
    s_waitcnt vmcnt(7)
    s_cmp_lt_i32 s72, -62
    s_cbranch_scc1 L_f16
    s_waitcnt vmcnt(5)
    s_cmp_lt_i32 s72, -30
    s_cbranch_scc1 L_f16
    s_waitcnt vmcnt(4)
    s_cmp_le_i32 s72, 30
    s_cbranch_scc1 L_f16
    s_waitcnt vmcnt(3)
L_f16:
    buffer_load_dwordx4 v[188:191], v10, s[44:47], s43 offen nt
    s_xor_b32 s43, s27, 262144
    v_add_f32_dpp v35, v32, v32 row_ror:8 row_mask:0xf bank_mask:0x3
    v_add_f32_dpp v35, v33, v33 row_ror:8 row_mask:0xf bank_mask:0xc
    v_add_f32_dpp v37, v34, v34 row_shl:4 row_mask:0xf bank_mask:0x5
    s_nop 0
    v_add_f32_dpp v37, v35, v35 row_shr:4 row_mask:0xf bank_mask:0xa
    v_add_f32_dpp v40, v36, v36 quad_perm:[2,3,0,1] row_mask:0xf bank_mask:0xf
    s_nop 0
    v_add_f32_dpp v41, v37, v37 quad_perm:[2,3,0,1] row_mask:0xf bank_mask:0xf
    v_cndmask_b32 v39, v40, v41, s[10:11]
    v_add_f32_dpp v40, v38, v38 quad_perm:[1,0,3,2] row_mask:0xf bank_mask:0xf
    s_nop 0
    v_add_f32_dpp v41, v39, v39 quad_perm:[1,0,3,2] row_mask:0xf bank_mask:0xf
    v_cndmask_b32 v43, v40, v41, s[12:13]
    ds_read_b32 v47, v9 offset:4688
    ds_write_b32 v13, v43 offset:13312
    v_max_f32 v28, v28, v43
    v_dot2_f32_bf16 v32, v192, v24, 0
    v_dot2_f32_bf16 v32, v193, v25, v32
    v_dot2_f32_bf16 v32, v194, v26, v32
    v_dot2_f32_bf16 v32, v195, v27, v32
    s_waitcnt vmcnt(7)
    s_cmp_lt_i32 s72, -33
    s_cbranch_scc1 L_f17
    s_waitcnt vmcnt(5)
    s_cmp_lt_i32 s72, -1
    s_cbranch_scc1 L_f17
    s_waitcnt vmcnt(4)
    s_cmp_le_i32 s72, 1
    s_cbranch_scc1 L_f17
    s_waitcnt vmcnt(3)
L_f17:
    buffer_load_dwordx4 v[192:195], v10, s[44:47], s43 offen nt
    s_xor_b32 s43, s27, 266240
    s_waitcnt lgkmcnt(0)
    v_readfirstlane_b32 s72, v47
    v_dot2_f32_bf16 v33, v196, v24, 0
    v_dot2_f32_bf16 v33, v197, v25, v33
    v_dot2_f32_bf16 v33, v198, v26, v33
    v_dot2_f32_bf16 v33, v199, v27, v33
    s_waitcnt vmcnt(7)
    s_cmp_lt_i32 s72, -49
    s_cbranch_scc1 L_f18
    s_waitcnt vmcnt(5)
    s_cmp_lt_i32 s72, -17
    s_cbranch_scc1 L_f18
    s_waitcnt vmcnt(4)
    s_cmp_le_i32 s72, 17
    s_cbranch_scc1 L_f18
    s_waitcnt vmcnt(3)
L_f18:
    buffer_load_dwordx4 v[196:199], v10, s[44:47], s43 offen nt
    s_xor_b32 s43, s27, 270336
    v_add_f32_dpp v34, v32, v32 row_ror:8 row_mask:0xf bank_mask:0x3
    v_add_f32_dpp v34, v33, v33 row_ror:8 row_mask:0xf bank_mask:0xc
    v_dot2_f32_bf16 v32, v200, v24, 0
    v_dot2_f32_bf16 v32, v201, v25, v32
    v_dot2_f32_bf16 v32, v202, v26, v32
    v_dot2_f32_bf16 v32, v203, v27, v32
    s_waitcnt vmcnt(7)
    s_cmp_lt_i32 s72, -41
    s_cbranch_scc1 L_f19
    s_waitcnt vmcnt(5)
    s_cmp_lt_i32 s72, -9
    s_cbranch_scc1 L_f19
    s_waitcnt vmcnt(4)
    s_cmp_le_i32 s72, 9
    s_cbranch_scc1 L_f19
    s_waitcnt vmcnt(3)
L_f19:
    buffer_load_dwordx4 v[200:203], v10, s[44:47], s43 offen nt
    s_xor_b32 s43, s27, 274432
    v_dot2_f32_bf16 v33, v204, v24, 0
    v_dot2_f32_bf16 v33, v205, v25, v33
    v_dot2_f32_bf16 v33, v206, v26, v33
    v_dot2_f32_bf16 v33, v207, v27, v33
    s_waitcnt vmcnt(7)
    s_cmp_lt_i32 s72, -57
    s_cbranch_scc1 L_f20
    s_waitcnt vmcnt(5)
    s_cmp_lt_i32 s72, -25
    s_cbranch_scc1 L_f20
    s_waitcnt vmcnt(4)
    s_cmp_le_i32 s72, 25
    s_cbranch_scc1 L_f20
    s_waitcnt vmcnt(3)
L_f20:
    buffer_load_dwordx4 v[204:207], v10, s[44:47], s43 offen nt
    s_xor_b32 s43, s27, 311296
    v_add_f32_dpp v35, v32, v32 row_ror:8 row_mask:0xf bank_mask:0x3
    v_add_f32_dpp v35, v33, v33 row_ror:8 row_mask:0xf bank_mask:0xc
    v_add_f32_dpp v36, v34, v34 row_shl:4 row_mask:0xf bank_mask:0x5
    s_nop 0
    v_add_f32_dpp v36, v35, v35 row_shr:4 row_mask:0xf bank_mask:0xa
    v_dot2_f32_bf16 v32, v208, v24, 0
    v_dot2_f32_bf16 v32, v209, v25, v32
    v_dot2_f32_bf16 v32, v210, v26, v32
    v_dot2_f32_bf16 v32, v211, v27, v32
    s_waitcnt vmcnt(7)
    s_cmp_lt_i32 s72, -37
    s_cbranch_scc1 L_f21
    s_waitcnt vmcnt(5)
    s_cmp_lt_i32 s72, -5
    s_cbranch_scc1 L_f21
    s_waitcnt vmcnt(4)
    s_cmp_le_i32 s72, 5
    s_cbranch_scc1 L_f21
    s_waitcnt vmcnt(3)
L_f21:
    buffer_load_dwordx4 v[208:211], v10, s[44:47], s43 offen nt
    s_xor_b32 s43, s27, 315392
    v_dot2_f32_bf16 v33, v212, v24, 0
    v_dot2_f32_bf16 v33, v213, v25, v33
    v_dot2_f32_bf16 v33, v214, v26, v33
    v_dot2_f32_bf16 v33, v215, v27, v33
    s_waitcnt vmcnt(7)
    s_cmp_lt_i32 s72, -53
    s_cbranch_scc1 L_f22
    s_waitcnt vmcnt(5)
    s_cmp_lt_i32 s72, -21
    s_cbranch_scc1 L_f22
    s_waitcnt vmcnt(4)
    s_cmp_le_i32 s72, 21
    s_cbranch_scc1 L_f22
    s_waitcnt vmcnt(3)
L_f22:
    buffer_load_dwordx4 v[212:215], v10, s[44:47], s43 offen nt
    s_xor_b32 s43, s27, 319488
    v_add_f32_dpp v34, v32, v32 row_ror:8 row_mask:0xf bank_mask:0x3
    v_add_f32_dpp v34, v33, v33 row_ror:8 row_mask:0xf bank_mask:0xc
    v_dot2_f32_bf16 v32, v216, v24, 0
    v_dot2_f32_bf16 v32, v217, v25, v32
    v_dot2_f32_bf16 v32, v218, v26, v32
    v_dot2_f32_bf16 v32, v219, v27, v32
    s_waitcnt vmcnt(7)
    s_cmp_lt_i32 s72, -45
    s_cbranch_scc1 L_f23
    s_waitcnt vmcnt(5)
    s_cmp_lt_i32 s72, -13
    s_cbranch_scc1 L_f23
    s_waitcnt vmcnt(4)
    s_cmp_le_i32 s72, 13
    s_cbranch_scc1 L_f23
    s_waitcnt vmcnt(3)
L_f23:
    buffer_load_dwordx4 v[216:219], v10, s[44:47], s43 offen nt
    s_xor_b32 s43, s27, 323584
    v_dot2_f32_bf16 v33, v220, v24, 0
    v_dot2_f32_bf16 v33, v221, v25, v33
    v_dot2_f32_bf16 v33, v222, v26, v33
    v_dot2_f32_bf16 v33, v223, v27, v33
    s_waitcnt vmcnt(7)
    s_cmp_lt_i32 s72, -61
    s_cbranch_scc1 L_f24
    s_waitcnt vmcnt(5)
    s_cmp_lt_i32 s72, -29
    s_cbranch_scc1 L_f24
    s_waitcnt vmcnt(4)
    s_cmp_le_i32 s72, 29
    s_cbranch_scc1 L_f24
    s_waitcnt vmcnt(3)
L_f24:
    buffer_load_dwordx4 v[220:223], v10, s[44:47], s43 offen nt
    s_xor_b32 s43, s27, 458752
    v_add_f32_dpp v35, v32, v32 row_ror:8 row_mask:0xf bank_mask:0x3
    v_add_f32_dpp v35, v33, v33 row_ror:8 row_mask:0xf bank_mask:0xc
    v_add_f32_dpp v37, v34, v34 row_shl:4 row_mask:0xf bank_mask:0x5
    s_nop 0
    v_add_f32_dpp v37, v35, v35 row_shr:4 row_mask:0xf bank_mask:0xa
    v_add_f32_dpp v40, v36, v36 quad_perm:[2,3,0,1] row_mask:0xf bank_mask:0xf
    s_nop 0
    v_add_f32_dpp v41, v37, v37 quad_perm:[2,3,0,1] row_mask:0xf bank_mask:0xf
    v_cndmask_b32 v38, v40, v41, s[10:11]
    ds_read_b32 v47, v9 offset:4688
    v_dot2_f32_bf16 v32, v224, v24, 0
    v_dot2_f32_bf16 v32, v225, v25, v32
    v_dot2_f32_bf16 v32, v226, v26, v32
    v_dot2_f32_bf16 v32, v227, v27, v32
    s_waitcnt vmcnt(7)
    s_cmp_lt_i32 s72, -35
    s_cbranch_scc1 L_f25
    s_waitcnt vmcnt(5)
    s_cmp_lt_i32 s72, -3
    s_cbranch_scc1 L_f25
    s_waitcnt vmcnt(4)
    s_cmp_le_i32 s72, 3
    s_cbranch_scc1 L_f25
    s_waitcnt vmcnt(3)
L_f25:
    buffer_load_dwordx4 v[224:227], v10, s[44:47], s43 offen nt
    s_xor_b32 s43, s27, 462848
    s_waitcnt lgkmcnt(0)
    v_readfirstlane_b32 s72, v47
    v_dot2_f32_bf16 v33, v228, v24, 0
    v_dot2_f32_bf16 v33, v229, v25, v33
    v_dot2_f32_bf16 v33, v230, v26, v33
    v_dot2_f32_bf16 v33, v231, v27, v33
    s_waitcnt vmcnt(7)
    s_cmp_lt_i32 s72, -51
    s_cbranch_scc1 L_f26
    s_waitcnt vmcnt(5)
    s_cmp_lt_i32 s72, -19
    s_cbranch_scc1 L_f26
    s_waitcnt vmcnt(4)
    s_cmp_le_i32 s72, 19
    s_cbranch_scc1 L_f26
    s_waitcnt vmcnt(3)
L_f26:
    buffer_load_dwordx4 v[228:231], v10, s[44:47], s43 offen nt
    s_xor_b32 s43, s27, 466944
    v_add_f32_dpp v34, v32, v32 row_ror:8 row_mask:0xf bank_mask:0x3
    v_add_f32_dpp v34, v33, v33 row_ror:8 row_mask:0xf bank_mask:0xc
    v_dot2_f32_bf16 v32, v232, v24, 0
    v_dot2_f32_bf16 v32, v233, v25, v32
    v_dot2_f32_bf16 v32, v234, v26, v32
    v_dot2_f32_bf16 v32, v235, v27, v32
    s_waitcnt vmcnt(7)
    s_cmp_lt_i32 s72, -43
    s_cbranch_scc1 L_f27
    s_waitcnt vmcnt(5)
    s_cmp_lt_i32 s72, -11
    s_cbranch_scc1 L_f27
    s_waitcnt vmcnt(4)
    s_cmp_le_i32 s72, 11
    s_cbranch_scc1 L_f27
    s_waitcnt vmcnt(3)
L_f27:
    buffer_load_dwordx4 v[232:235], v10, s[44:47], s43 offen nt
    s_xor_b32 s43, s27, 471040
    v_dot2_f32_bf16 v33, v236, v24, 0
    v_dot2_f32_bf16 v33, v237, v25, v33
    v_dot2_f32_bf16 v33, v238, v26, v33
    v_dot2_f32_bf16 v33, v239, v27, v33
    s_waitcnt vmcnt(7)
    s_cmp_lt_i32 s72, -59
    s_cbranch_scc1 L_f28
    s_waitcnt vmcnt(5)
    s_cmp_lt_i32 s72, -27
    s_cbranch_scc1 L_f28
    s_waitcnt vmcnt(4)
    s_cmp_le_i32 s72, 27
    s_cbranch_scc1 L_f28
    s_waitcnt vmcnt(3)
L_f28:
    buffer_load_dwordx4 v[236:239], v10, s[44:47], s43 offen nt
    s_xor_b32 s43, s27, 507904
    v_add_f32_dpp v35, v32, v32 row_ror:8 row_mask:0xf bank_mask:0x3
    v_add_f32_dpp v35, v33, v33 row_ror:8 row_mask:0xf bank_mask:0xc
    v_add_f32_dpp v36, v34, v34 row_shl:4 row_mask:0xf bank_mask:0x5
    s_nop 0
    v_add_f32_dpp v36, v35, v35 row_shr:4 row_mask:0xf bank_mask:0xa
    v_dot2_f32_bf16 v32, v240, v24, 0
    v_dot2_f32_bf16 v32, v241, v25, v32
    v_dot2_f32_bf16 v32, v242, v26, v32
    v_dot2_f32_bf16 v32, v243, v27, v32
    s_waitcnt vmcnt(7)
    s_cmp_lt_i32 s72, -39
    s_cbranch_scc1 L_f29
    s_waitcnt vmcnt(5)
    s_cmp_lt_i32 s72, -7
    s_cbranch_scc1 L_f29
    s_waitcnt vmcnt(4)
    s_cmp_le_i32 s72, 7
    s_cbranch_scc1 L_f29
    s_waitcnt vmcnt(3)
L_f29:
    buffer_load_dwordx4 v[240:243], v10, s[44:47], s43 offen nt
    s_xor_b32 s43, s27, 512000
    v_dot2_f32_bf16 v33, v244, v24, 0
    v_dot2_f32_bf16 v33, v245, v25, v33
    v_dot2_f32_bf16 v33, v246, v26, v33
    v_dot2_f32_bf16 v33, v247, v27, v33
    s_waitcnt vmcnt(7)
    s_cmp_lt_i32 s72, -55
    s_cbranch_scc1 L_f30
    s_waitcnt vmcnt(5)
    s_cmp_lt_i32 s72, -23
    s_cbranch_scc1 L_f30
    s_waitcnt vmcnt(4)
    s_cmp_le_i32 s72, 23
    s_cbranch_scc1 L_f30
    s_waitcnt vmcnt(3)
L_f30:
    buffer_load_dwordx4 v[244:247], v10, s[44:47], s43 offen nt
    s_xor_b32 s43, s27, 516096
    v_add_f32_dpp v34, v32, v32 row_ror:8 row_mask:0xf bank_mask:0x3
    v_add_f32_dpp v34, v33, v33 row_ror:8 row_mask:0xf bank_mask:0xc
    v_dot2_f32_bf16 v32, v248, v24, 0
    v_dot2_f32_bf16 v32, v249, v25, v32
    v_dot2_f32_bf16 v32, v250, v26, v32
    v_dot2_f32_bf16 v32, v251, v27, v32
    s_waitcnt vmcnt(7)
    s_cmp_lt_i32 s72, -47
    s_cbranch_scc1 L_f31
    s_waitcnt vmcnt(5)
    s_cmp_lt_i32 s72, -15
    s_cbranch_scc1 L_f31
    s_waitcnt vmcnt(4)
    s_cmp_le_i32 s72, 15
    s_cbranch_scc1 L_f31
    s_waitcnt vmcnt(3)
L_f31:
    buffer_load_dwordx4 v[248:251], v10, s[44:47], s43 offen nt
    s_xor_b32 s43, s27, 520192
    v_dot2_f32_bf16 v33, v252, v24, 0
    v_dot2_f32_bf16 v33, v253, v25, v33
    v_dot2_f32_bf16 v33, v254, v26, v33
    v_dot2_f32_bf16 v33, v255, v27, v33
    s_waitcnt vmcnt(7)
    s_cmp_lt_i32 s72, -63
    s_cbranch_scc1 L_f32
    s_waitcnt vmcnt(5)
    s_cmp_lt_i32 s72, -31
    s_cbranch_scc1 L_f32
    s_waitcnt vmcnt(4)
    s_cmp_le_i32 s72, 31
    s_cbranch_scc1 L_f32
    s_waitcnt vmcnt(3)
L_f32:
    buffer_load_dwordx4 v[252:255], v10, s[44:47], s43 offen nt
    s_add_u32 s26, s26, 1
    s_mov_b32 s27, s28
    s_bfe_u32 s8, s26, 0x10000
    s_lshl_b32 s8, s8, 19
    s_or_b32 s27, s27, s8
    s_bfe_u32 s8, s26, 0x10001
    s_lshl_b32 s8, s8, 20
    s_or_b32 s27, s27, s8
    s_bfe_u32 s8, s26, 0x10002
    s_lshl_b32 s8, s8, 22
    s_or_b32 s27, s27, s8
    s_xor_b32 s43, s27, 0
    v_add_f32_dpp v35, v32, v32 row_ror:8 row_mask:0xf bank_mask:0x3
    v_add_f32_dpp v35, v33, v33 row_ror:8 row_mask:0xf bank_mask:0xc
    v_add_f32_dpp v37, v34, v34 row_shl:4 row_mask:0xf bank_mask:0x5
    s_nop 0
    v_add_f32_dpp v37, v35, v35 row_shr:4 row_mask:0xf bank_mask:0xa
    v_add_f32_dpp v40, v36, v36 quad_perm:[2,3,0,1] row_mask:0xf bank_mask:0xf
    s_nop 0
    v_add_f32_dpp v41, v37, v37 quad_perm:[2,3,0,1] row_mask:0xf bank_mask:0xf
    v_cndmask_b32 v39, v40, v41, s[10:11]
    v_add_f32_dpp v40, v38, v38 quad_perm:[1,0,3,2] row_mask:0xf bank_mask:0xf
    s_nop 0
    v_add_f32_dpp v41, v39, v39 quad_perm:[1,0,3,2] row_mask:0xf bank_mask:0xf
    v_cndmask_b32 v43, v40, v41, s[12:13]
    ds_write_b32 v13, v43 offset:13568
    v_max_f32 v28, v28, v43
    v_add_u32 v13, 512, v13
    s_sub_u32 s15, s15, 1
    s_cmp_lg_u32 s15, 0
    s_cbranch_scc1 L_k
    s_memrealtime s[78:79]
    ds_read_b32 v47, v9 offset:4688
    v_dot2_f32_bf16 v32, v128, v24, 0
    v_dot2_f32_bf16 v32, v129, v25, v32
    v_dot2_f32_bf16 v32, v130, v26, v32
    v_dot2_f32_bf16 v32, v131, v27, v32
    s_waitcnt vmcnt(7)
    s_cmp_lt_i32 s72, -32
    s_cbranch_scc1 L_f33
    s_waitcnt vmcnt(5)
    s_cmp_lt_i32 s72, 0
    s_cbranch_scc1 L_f33
    s_waitcnt vmcnt(4)
    s_cmp_le_i32 s72, 0
    s_cbranch_scc1 L_f33
    s_waitcnt vmcnt(3)
L_f33:
    buffer_load_dwordx4 v[128:131], v10, s[48:51], s43 offen nt
    s_xor_b32 s43, s27, 4096
    s_waitcnt lgkmcnt(0)
    v_readfirstlane_b32 s72, v47
    v_mov_b32 v44, s78
    s_mov_b64 exec, 1
    ds_write_b32 v14, v44 offset:4704
    ds_add_u32 v1, v45 offset:4656
    s_mov_b64 exec, -1
    v_add_u32 v14, 16, v14
    v_dot2_f32_bf16 v33, v132, v24, 0
    v_dot2_f32_bf16 v33, v133, v25, v33
    v_dot2_f32_bf16 v33, v134, v26, v33
    v_dot2_f32_bf16 v33, v135, v27, v33
    s_waitcnt vmcnt(7)
    s_cmp_lt_i32 s72, -48
    s_cbranch_scc1 L_f34
    s_waitcnt vmcnt(5)
    s_cmp_lt_i32 s72, -16
    s_cbranch_scc1 L_f34
    s_waitcnt vmcnt(4)
    s_cmp_le_i32 s72, 16
    s_cbranch_scc1 L_f34
    s_waitcnt vmcnt(3)
L_f34:
    buffer_load_dwordx4 v[132:135], v10, s[48:51], s43 offen nt
    s_xor_b32 s43, s27, 8192
    v_add_f32_dpp v34, v32, v32 row_ror:8 row_mask:0xf bank_mask:0x3
    v_add_f32_dpp v34, v33, v33 row_ror:8 row_mask:0xf bank_mask:0xc
    v_dot2_f32_bf16 v32, v136, v24, 0
    v_dot2_f32_bf16 v32, v137, v25, v32
    v_dot2_f32_bf16 v32, v138, v26, v32
    v_dot2_f32_bf16 v32, v139, v27, v32
    s_waitcnt vmcnt(7)
    s_cmp_lt_i32 s72, -40
    s_cbranch_scc1 L_f35
    s_waitcnt vmcnt(5)
    s_cmp_lt_i32 s72, -8
    s_cbranch_scc1 L_f35
    s_waitcnt vmcnt(4)
    s_cmp_le_i32 s72, 8
    s_cbranch_scc1 L_f35
    s_waitcnt vmcnt(3)
L_f35:
    buffer_load_dwordx4 v[136:139], v10, s[48:51], s43 offen nt
    s_xor_b32 s43, s27, 12288
    v_dot2_f32_bf16 v33, v140, v24, 0
    v_dot2_f32_bf16 v33, v141, v25, v33
    v_dot2_f32_bf16 v33, v142, v26, v33
    v_dot2_f32_bf16 v33, v143, v27, v33
    s_waitcnt vmcnt(7)
    s_cmp_lt_i32 s72, -56
    s_cbranch_scc1 L_f36
    s_waitcnt vmcnt(5)
    s_cmp_lt_i32 s72, -24
    s_cbranch_scc1 L_f36
    s_waitcnt vmcnt(4)
    s_cmp_le_i32 s72, 24
    s_cbranch_scc1 L_f36
    s_waitcnt vmcnt(3)
L_f36:
    buffer_load_dwordx4 v[140:143], v10, s[48:51], s43 offen nt
    s_xor_b32 s43, s27, 49152
    v_add_f32_dpp v35, v32, v32 row_ror:8 row_mask:0xf bank_mask:0x3
    v_add_f32_dpp v35, v33, v33 row_ror:8 row_mask:0xf bank_mask:0xc
    v_add_f32_dpp v36, v34, v34 row_shl:4 row_mask:0xf bank_mask:0x5
    s_nop 0
    v_add_f32_dpp v36, v35, v35 row_shr:4 row_mask:0xf bank_mask:0xa
    v_dot2_f32_bf16 v32, v144, v24, 0
    v_dot2_f32_bf16 v32, v145, v25, v32
    v_dot2_f32_bf16 v32, v146, v26, v32
    v_dot2_f32_bf16 v32, v147, v27, v32
    s_waitcnt vmcnt(7)
    s_cmp_lt_i32 s72, -36
    s_cbranch_scc1 L_f37
    s_waitcnt vmcnt(5)
    s_cmp_lt_i32 s72, -4
    s_cbranch_scc1 L_f37
    s_waitcnt vmcnt(4)
    s_cmp_le_i32 s72, 4
    s_cbranch_scc1 L_f37
    s_waitcnt vmcnt(3)
L_f37:
    buffer_load_dwordx4 v[144:147], v10, s[48:51], s43 offen nt
    s_xor_b32 s43, s27, 53248
    v_dot2_f32_bf16 v33, v148, v24, 0
    v_dot2_f32_bf16 v33, v149, v25, v33
    v_dot2_f32_bf16 v33, v150, v26, v33
    v_dot2_f32_bf16 v33, v151, v27, v33
    s_waitcnt vmcnt(7)
    s_cmp_lt_i32 s72, -52
    s_cbranch_scc1 L_f38
    s_waitcnt vmcnt(5)
    s_cmp_lt_i32 s72, -20
    s_cbranch_scc1 L_f38
    s_waitcnt vmcnt(4)
    s_cmp_le_i32 s72, 20
    s_cbranch_scc1 L_f38
    s_waitcnt vmcnt(3)
L_f38:
    buffer_load_dwordx4 v[148:151], v10, s[48:51], s43 offen nt
    s_xor_b32 s43, s27, 57344
    v_add_f32_dpp v34, v32, v32 row_ror:8 row_mask:0xf bank_mask:0x3
    v_add_f32_dpp v34, v33, v33 row_ror:8 row_mask:0xf bank_mask:0xc
    v_dot2_f32_bf16 v32, v152, v24, 0
    v_dot2_f32_bf16 v32, v153, v25, v32
    v_dot2_f32_bf16 v32, v154, v26, v32
    v_dot2_f32_bf16 v32, v155, v27, v32
    s_waitcnt vmcnt(7)
    s_cmp_lt_i32 s72, -44
    s_cbranch_scc1 L_f39
    s_waitcnt vmcnt(5)
    s_cmp_lt_i32 s72, -12
    s_cbranch_scc1 L_f39
    s_waitcnt vmcnt(4)
    s_cmp_le_i32 s72, 12
    s_cbranch_scc1 L_f39
    s_waitcnt vmcnt(3)
L_f39:
    buffer_load_dwordx4 v[152:155], v10, s[48:51], s43 offen nt
    s_xor_b32 s43, s27, 61440
    v_dot2_f32_bf16 v33, v156, v24, 0
    v_dot2_f32_bf16 v33, v157, v25, v33
    v_dot2_f32_bf16 v33, v158, v26, v33
    v_dot2_f32_bf16 v33, v159, v27, v33
    s_waitcnt vmcnt(7)
    s_cmp_lt_i32 s72, -60
    s_cbranch_scc1 L_f40
    s_waitcnt vmcnt(5)
    s_cmp_lt_i32 s72, -28
    s_cbranch_scc1 L_f40
    s_waitcnt vmcnt(4)
    s_cmp_le_i32 s72, 28
    s_cbranch_scc1 L_f40
    s_waitcnt vmcnt(3)
L_f40:
    buffer_load_dwordx4 v[156:159], v10, s[48:51], s43 offen nt
    s_xor_b32 s43, s27, 196608
    v_add_f32_dpp v35, v32, v32 row_ror:8 row_mask:0xf bank_mask:0x3
    v_add_f32_dpp v35, v33, v33 row_ror:8 row_mask:0xf bank_mask:0xc
    v_add_f32_dpp v37, v34, v34 row_shl:4 row_mask:0xf bank_mask:0x5
    s_nop 0
    v_add_f32_dpp v37, v35, v35 row_shr:4 row_mask:0xf bank_mask:0xa
    v_add_f32_dpp v40, v36, v36 quad_perm:[2,3,0,1] row_mask:0xf bank_mask:0xf
    s_nop 0
    v_add_f32_dpp v41, v37, v37 quad_perm:[2,3,0,1] row_mask:0xf bank_mask:0xf
    v_cndmask_b32 v38, v40, v41, s[10:11]
    ds_read_b32 v47, v9 offset:4688
    v_dot2_f32_bf16 v32, v160, v24, 0
    v_dot2_f32_bf16 v32, v161, v25, v32
    v_dot2_f32_bf16 v32, v162, v26, v32
    v_dot2_f32_bf16 v32, v163, v27, v32
    s_waitcnt vmcnt(7)
    s_cmp_lt_i32 s72, -34
    s_cbranch_scc1 L_f41
    s_waitcnt vmcnt(5)
    s_cmp_lt_i32 s72, -2
    s_cbranch_scc1 L_f41
    s_waitcnt vmcnt(4)
    s_cmp_le_i32 s72, 2
    s_cbranch_scc1 L_f41
    s_waitcnt vmcnt(3)
L_f41:
    buffer_load_dwordx4 v[160:163], v10, s[48:51], s43 offen nt
    s_xor_b32 s43, s27, 200704
    s_waitcnt lgkmcnt(0)
    v_readfirstlane_b32 s72, v47
    v_dot2_f32_bf16 v33, v164, v24, 0
    v_dot2_f32_bf16 v33, v165, v25, v33
    v_dot2_f32_bf16 v33, v166, v26, v33
    v_dot2_f32_bf16 v33, v167, v27, v33
    s_waitcnt vmcnt(7)
    s_cmp_lt_i32 s72, -50
    s_cbranch_scc1 L_f42
    s_waitcnt vmcnt(5)
    s_cmp_lt_i32 s72, -18
    s_cbranch_scc1 L_f42
    s_waitcnt vmcnt(4)
    s_cmp_le_i32 s72, 18
    s_cbranch_scc1 L_f42
    s_waitcnt vmcnt(3)
L_f42:
    buffer_load_dwordx4 v[164:167], v10, s[48:51], s43 offen nt
    s_xor_b32 s43, s27, 204800
    v_add_f32_dpp v34, v32, v32 row_ror:8 row_mask:0xf bank_mask:0x3
    v_add_f32_dpp v34, v33, v33 row_ror:8 row_mask:0xf bank_mask:0xc
    v_dot2_f32_bf16 v32, v168, v24, 0
    v_dot2_f32_bf16 v32, v169, v25, v32
    v_dot2_f32_bf16 v32, v170, v26, v32
    v_dot2_f32_bf16 v32, v171, v27, v32
    s_waitcnt vmcnt(7)
    s_cmp_lt_i32 s72, -42
    s_cbranch_scc1 L_f43
    s_waitcnt vmcnt(5)
    s_cmp_lt_i32 s72, -10
    s_cbranch_scc1 L_f43
    s_waitcnt vmcnt(4)
    s_cmp_le_i32 s72, 10
    s_cbranch_scc1 L_f43
    s_waitcnt vmcnt(3)
L_f43:
    buffer_load_dwordx4 v[168:171], v10, s[48:51], s43 offen nt
    s_xor_b32 s43, s27, 208896
    v_dot2_f32_bf16 v33, v172, v24, 0
    v_dot2_f32_bf16 v33, v173, v25, v33
    v_dot2_f32_bf16 v33, v174, v26, v33
    v_dot2_f32_bf16 v33, v175, v27, v33
    s_waitcnt vmcnt(7)
    s_cmp_lt_i32 s72, -58
    s_cbranch_scc1 L_f44
    s_waitcnt vmcnt(5)
    s_cmp_lt_i32 s72, -26
    s_cbranch_scc1 L_f44
    s_waitcnt vmcnt(4)
    s_cmp_le_i32 s72, 26
    s_cbranch_scc1 L_f44
    s_waitcnt vmcnt(3)
L_f44:
    buffer_load_dwordx4 v[172:175], v10, s[48:51], s43 offen nt
    s_xor_b32 s43, s27, 245760
    v_add_f32_dpp v35, v32, v32 row_ror:8 row_mask:0xf bank_mask:0x3
    v_add_f32_dpp v35, v33, v33 row_ror:8 row_mask:0xf bank_mask:0xc
    v_add_f32_dpp v36, v34, v34 row_shl:4 row_mask:0xf bank_mask:0x5
    s_nop 0
    v_add_f32_dpp v36, v35, v35 row_shr:4 row_mask:0xf bank_mask:0xa
    v_dot2_f32_bf16 v32, v176, v24, 0
    v_dot2_f32_bf16 v32, v177, v25, v32
    v_dot2_f32_bf16 v32, v178, v26, v32
    v_dot2_f32_bf16 v32, v179, v27, v32
    s_waitcnt vmcnt(7)
    s_cmp_lt_i32 s72, -38
    s_cbranch_scc1 L_f45
    s_waitcnt vmcnt(5)
    s_cmp_lt_i32 s72, -6
    s_cbranch_scc1 L_f45
    s_waitcnt vmcnt(4)
    s_cmp_le_i32 s72, 6
    s_cbranch_scc1 L_f45
    s_waitcnt vmcnt(3)
L_f45:
    buffer_load_dwordx4 v[176:179], v10, s[48:51], s43 offen nt
    s_xor_b32 s43, s27, 249856
    v_dot2_f32_bf16 v33, v180, v24, 0
    v_dot2_f32_bf16 v33, v181, v25, v33
    v_dot2_f32_bf16 v33, v182, v26, v33
    v_dot2_f32_bf16 v33, v183, v27, v33
    s_waitcnt vmcnt(7)
    s_cmp_lt_i32 s72, -54
    s_cbranch_scc1 L_f46
    s_waitcnt vmcnt(5)
    s_cmp_lt_i32 s72, -22
    s_cbranch_scc1 L_f46
    s_waitcnt vmcnt(4)
    s_cmp_le_i32 s72, 22
    s_cbranch_scc1 L_f46
    s_waitcnt vmcnt(3)
L_f46:
    buffer_load_dwordx4 v[180:183], v10, s[48:51], s43 offen nt
    s_xor_b32 s43, s27, 253952
    v_add_f32_dpp v34, v32, v32 row_ror:8 row_mask:0xf bank_mask:0x3
    v_add_f32_dpp v34, v33, v33 row_ror:8 row_mask:0xf bank_mask:0xc
    v_dot2_f32_bf16 v32, v184, v24, 0
    v_dot2_f32_bf16 v32, v185, v25, v32
    v_dot2_f32_bf16 v32, v186, v26, v32
    v_dot2_f32_bf16 v32, v187, v27, v32
    s_waitcnt vmcnt(7)
    s_cmp_lt_i32 s72, -46
    s_cbranch_scc1 L_f47
    s_waitcnt vmcnt(5)
    s_cmp_lt_i32 s72, -14
    s_cbranch_scc1 L_f47
    s_waitcnt vmcnt(4)
    s_cmp_le_i32 s72, 14
    s_cbranch_scc1 L_f47
    s_waitcnt vmcnt(3)
L_f47:
    buffer_load_dwordx4 v[184:187], v10, s[48:51], s43 offen nt
    s_xor_b32 s43, s27, 258048
    v_dot2_f32_bf16 v33, v188, v24, 0
    v_dot2_f32_bf16 v33, v189, v25, v33
    v_dot2_f32_bf16 v33, v190, v26, v33
    v_dot2_f32_bf16 v33, v191, v27, v33
    s_waitcnt vmcnt(7)
    s_cmp_lt_i32 s72, -62
    s_cbranch_scc1 L_f48
    s_waitcnt vmcnt(5)
    s_cmp_lt_i32 s72, -30
    s_cbranch_scc1 L_f48
    s_waitcnt vmcnt(4)
    s_cmp_le_i32 s72, 30
    s_cbranch_scc1 L_f48
    s_waitcnt vmcnt(3)
L_f48:
    buffer_load_dwordx4 v[188:191], v10, s[48:51], s43 offen nt
    s_xor_b32 s43, s27, 262144
    v_add_f32_dpp v35, v32, v32 row_ror:8 row_mask:0xf bank_mask:0x3
    v_add_f32_dpp v35, v33, v33 row_ror:8 row_mask:0xf bank_mask:0xc
    v_add_f32_dpp v37, v34, v34 row_shl:4 row_mask:0xf bank_mask:0x5
    s_nop 0
    v_add_f32_dpp v37, v35, v35 row_shr:4 row_mask:0xf bank_mask:0xa
    v_add_f32_dpp v40, v36, v36 quad_perm:[2,3,0,1] row_mask:0xf bank_mask:0xf
    s_nop 0
    v_add_f32_dpp v41, v37, v37 quad_perm:[2,3,0,1] row_mask:0xf bank_mask:0xf
    v_cndmask_b32 v39, v40, v41, s[10:11]
    v_add_f32_dpp v40, v38, v38 quad_perm:[1,0,3,2] row_mask:0xf bank_mask:0xf
    s_nop 0
    v_add_f32_dpp v41, v39, v39 quad_perm:[1,0,3,2] row_mask:0xf bank_mask:0xf
    v_cndmask_b32 v43, v40, v41, s[12:13]
    ds_read_b32 v47, v9 offset:4688
    ds_write_b32 v13, v43 offset:13312
    v_max_f32 v28, v28, v43
    v_dot2_f32_bf16 v32, v192, v24, 0
    v_dot2_f32_bf16 v32, v193, v25, v32
    v_dot2_f32_bf16 v32, v194, v26, v32
    v_dot2_f32_bf16 v32, v195, v27, v32
    s_waitcnt vmcnt(7)
    s_cmp_lt_i32 s72, -33
    s_cbranch_scc1 L_f49
    s_waitcnt vmcnt(5)
    s_cmp_lt_i32 s72, -1
    s_cbranch_scc1 L_f49
    s_waitcnt vmcnt(4)
    s_cmp_le_i32 s72, 1
    s_cbranch_scc1 L_f49
    s_waitcnt vmcnt(3)
L_f49:
    buffer_load_dwordx4 v[192:195], v10, s[48:51], s43 offen nt
    s_xor_b32 s43, s27, 266240
    s_waitcnt lgkmcnt(0)
    v_readfirstlane_b32 s72, v47
    v_dot2_f32_bf16 v33, v196, v24, 0
    v_dot2_f32_bf16 v33, v197, v25, v33
    v_dot2_f32_bf16 v33, v198, v26, v33
    v_dot2_f32_bf16 v33, v199, v27, v33
    s_waitcnt vmcnt(7)
    s_cmp_lt_i32 s72, -49
    s_cbranch_scc1 L_f50
    s_waitcnt vmcnt(5)
    s_cmp_lt_i32 s72, -17
    s_cbranch_scc1 L_f50
    s_waitcnt vmcnt(4)
    s_cmp_le_i32 s72, 17
    s_cbranch_scc1 L_f50
    s_waitcnt vmcnt(3)
L_f50:
    buffer_load_dwordx4 v[196:199], v10, s[48:51], s43 offen nt
    s_xor_b32 s43, s27, 270336
    v_add_f32_dpp v34, v32, v32 row_ror:8 row_mask:0xf bank_mask:0x3
    v_add_f32_dpp v34, v33, v33 row_ror:8 row_mask:0xf bank_mask:0xc
    v_dot2_f32_bf16 v32, v200, v24, 0
    v_dot2_f32_bf16 v32, v201, v25, v32
    v_dot2_f32_bf16 v32, v202, v26, v32
    v_dot2_f32_bf16 v32, v203, v27, v32
    s_waitcnt vmcnt(7)
    s_cmp_lt_i32 s72, -41
    s_cbranch_scc1 L_f51
    s_waitcnt vmcnt(5)
    s_cmp_lt_i32 s72, -9
    s_cbranch_scc1 L_f51
    s_waitcnt vmcnt(4)
    s_cmp_le_i32 s72, 9
    s_cbranch_scc1 L_f51
    s_waitcnt vmcnt(3)
L_f51:
    buffer_load_dwordx4 v[200:203], v10, s[48:51], s43 offen nt
    s_xor_b32 s43, s27, 274432
    v_dot2_f32_bf16 v33, v204, v24, 0
    v_dot2_f32_bf16 v33, v205, v25, v33
    v_dot2_f32_bf16 v33, v206, v26, v33
    v_dot2_f32_bf16 v33, v207, v27, v33
    s_waitcnt vmcnt(7)
    s_cmp_lt_i32 s72, -57
    s_cbranch_scc1 L_f52
    s_waitcnt vmcnt(5)
    s_cmp_lt_i32 s72, -25
    s_cbranch_scc1 L_f52
    s_waitcnt vmcnt(4)
    s_cmp_le_i32 s72, 25
    s_cbranch_scc1 L_f52
    s_waitcnt vmcnt(3)
L_f52:
    buffer_load_dwordx4 v[204:207], v10, s[48:51], s43 offen nt
    s_xor_b32 s43, s27, 311296
    v_add_f32_dpp v35, v32, v32 row_ror:8 row_mask:0xf bank_mask:0x3
    v_add_f32_dpp v35, v33, v33 row_ror:8 row_mask:0xf bank_mask:0xc
    v_add_f32_dpp v36, v34, v34 row_shl:4 row_mask:0xf bank_mask:0x5
    s_nop 0
    v_add_f32_dpp v36, v35, v35 row_shr:4 row_mask:0xf bank_mask:0xa
    v_dot2_f32_bf16 v32, v208, v24, 0
    v_dot2_f32_bf16 v32, v209, v25, v32
    v_dot2_f32_bf16 v32, v210, v26, v32
    v_dot2_f32_bf16 v32, v211, v27, v32
    s_waitcnt vmcnt(7)
    s_cmp_lt_i32 s72, -37
    s_cbranch_scc1 L_f53
    s_waitcnt vmcnt(5)
    s_cmp_lt_i32 s72, -5
    s_cbranch_scc1 L_f53
    s_waitcnt vmcnt(4)
    s_cmp_le_i32 s72, 5
    s_cbranch_scc1 L_f53
    s_waitcnt vmcnt(3)
L_f53:
    buffer_load_dwordx4 v[208:211], v10, s[48:51], s43 offen nt
    s_xor_b32 s43, s27, 315392
    v_dot2_f32_bf16 v33, v212, v24, 0
    v_dot2_f32_bf16 v33, v213, v25, v33
    v_dot2_f32_bf16 v33, v214, v26, v33
    v_dot2_f32_bf16 v33, v215, v27, v33
    s_waitcnt vmcnt(7)
    s_cmp_lt_i32 s72, -53
    s_cbranch_scc1 L_f54
    s_waitcnt vmcnt(5)
    s_cmp_lt_i32 s72, -21
    s_cbranch_scc1 L_f54
    s_waitcnt vmcnt(4)
    s_cmp_le_i32 s72, 21
    s_cbranch_scc1 L_f54
    s_waitcnt vmcnt(3)
L_f54:
    buffer_load_dwordx4 v[212:215], v10, s[48:51], s43 offen nt
    s_xor_b32 s43, s27, 319488
    v_add_f32_dpp v34, v32, v32 row_ror:8 row_mask:0xf bank_mask:0x3
    v_add_f32_dpp v34, v33, v33 row_ror:8 row_mask:0xf bank_mask:0xc
    v_dot2_f32_bf16 v32, v216, v24, 0
    v_dot2_f32_bf16 v32, v217, v25, v32
    v_dot2_f32_bf16 v32, v218, v26, v32
    v_dot2_f32_bf16 v32, v219, v27, v32
    s_waitcnt vmcnt(7)
    s_cmp_lt_i32 s72, -45
    s_cbranch_scc1 L_f55
    s_waitcnt vmcnt(5)
    s_cmp_lt_i32 s72, -13
    s_cbranch_scc1 L_f55
    s_waitcnt vmcnt(4)
    s_cmp_le_i32 s72, 13
    s_cbranch_scc1 L_f55
    s_waitcnt vmcnt(3)
L_f55:
    buffer_load_dwordx4 v[216:219], v10, s[48:51], s43 offen nt
    s_xor_b32 s43, s27, 323584
    v_dot2_f32_bf16 v33, v220, v24, 0
    v_dot2_f32_bf16 v33, v221, v25, v33
    v_dot2_f32_bf16 v33, v222, v26, v33
    v_dot2_f32_bf16 v33, v223, v27, v33
    s_waitcnt vmcnt(7)
    s_cmp_lt_i32 s72, -61
    s_cbranch_scc1 L_f56
    s_waitcnt vmcnt(5)
    s_cmp_lt_i32 s72, -29
    s_cbranch_scc1 L_f56
    s_waitcnt vmcnt(4)
    s_cmp_le_i32 s72, 29
    s_cbranch_scc1 L_f56
    s_waitcnt vmcnt(3)
L_f56:
    buffer_load_dwordx4 v[220:223], v10, s[48:51], s43 offen nt
    s_xor_b32 s43, s27, 458752
    v_add_f32_dpp v35, v32, v32 row_ror:8 row_mask:0xf bank_mask:0x3
    v_add_f32_dpp v35, v33, v33 row_ror:8 row_mask:0xf bank_mask:0xc
    v_add_f32_dpp v37, v34, v34 row_shl:4 row_mask:0xf bank_mask:0x5
    s_nop 0
    v_add_f32_dpp v37, v35, v35 row_shr:4 row_mask:0xf bank_mask:0xa
    v_add_f32_dpp v40, v36, v36 quad_perm:[2,3,0,1] row_mask:0xf bank_mask:0xf
    s_nop 0
    v_add_f32_dpp v41, v37, v37 quad_perm:[2,3,0,1] row_mask:0xf bank_mask:0xf
    v_cndmask_b32 v38, v40, v41, s[10:11]
    ds_read_b32 v47, v9 offset:4688
    v_dot2_f32_bf16 v32, v224, v24, 0
    v_dot2_f32_bf16 v32, v225, v25, v32
    v_dot2_f32_bf16 v32, v226, v26, v32
    v_dot2_f32_bf16 v32, v227, v27, v32
    s_waitcnt vmcnt(7)
    s_cmp_lt_i32 s72, -35
    s_cbranch_scc1 L_f57
    s_waitcnt vmcnt(5)
    s_cmp_lt_i32 s72, -3
    s_cbranch_scc1 L_f57
    s_waitcnt vmcnt(4)
    s_cmp_le_i32 s72, 3
    s_cbranch_scc1 L_f57
    s_waitcnt vmcnt(3)
L_f57:
    buffer_load_dwordx4 v[224:227], v10, s[48:51], s43 offen nt
    s_xor_b32 s43, s27, 462848
    s_waitcnt lgkmcnt(0)
    v_readfirstlane_b32 s72, v47
    v_dot2_f32_bf16 v33, v228, v24, 0
    v_dot2_f32_bf16 v33, v229, v25, v33
    v_dot2_f32_bf16 v33, v230, v26, v33
    v_dot2_f32_bf16 v33, v231, v27, v33
    s_waitcnt vmcnt(7)
    s_cmp_lt_i32 s72, -51
    s_cbranch_scc1 L_f58
    s_waitcnt vmcnt(5)
    s_cmp_lt_i32 s72, -19
    s_cbranch_scc1 L_f58
    s_waitcnt vmcnt(4)
    s_cmp_le_i32 s72, 19
    s_cbranch_scc1 L_f58
    s_waitcnt vmcnt(3)
L_f58:
    buffer_load_dwordx4 v[228:231], v10, s[48:51], s43 offen nt
    s_xor_b32 s43, s27, 466944
    v_add_f32_dpp v34, v32, v32 row_ror:8 row_mask:0xf bank_mask:0x3
    v_add_f32_dpp v34, v33, v33 row_ror:8 row_mask:0xf bank_mask:0xc
    v_dot2_f32_bf16 v32, v232, v24, 0
    v_dot2_f32_bf16 v32, v233, v25, v32
    v_dot2_f32_bf16 v32, v234, v26, v32
    v_dot2_f32_bf16 v32, v235, v27, v32
    s_waitcnt vmcnt(7)
    s_cmp_lt_i32 s72, -43
    s_cbranch_scc1 L_f59
    s_waitcnt vmcnt(5)
    s_cmp_lt_i32 s72, -11
    s_cbranch_scc1 L_f59
    s_waitcnt vmcnt(4)
    s_cmp_le_i32 s72, 11
    s_cbranch_scc1 L_f59
    s_waitcnt vmcnt(3)
L_f59:
    buffer_load_dwordx4 v[232:235], v10, s[48:51], s43 offen nt
    s_xor_b32 s43, s27, 471040
    v_dot2_f32_bf16 v33, v236, v24, 0
    v_dot2_f32_bf16 v33, v237, v25, v33
    v_dot2_f32_bf16 v33, v238, v26, v33
    v_dot2_f32_bf16 v33, v239, v27, v33
    s_waitcnt vmcnt(7)
    s_cmp_lt_i32 s72, -59
    s_cbranch_scc1 L_f60
    s_waitcnt vmcnt(5)
    s_cmp_lt_i32 s72, -27
    s_cbranch_scc1 L_f60
    s_waitcnt vmcnt(4)
    s_cmp_le_i32 s72, 27
    s_cbranch_scc1 L_f60
    s_waitcnt vmcnt(3)
L_f60:
    buffer_load_dwordx4 v[236:239], v10, s[48:51], s43 offen nt
    s_xor_b32 s43, s27, 507904
    v_add_f32_dpp v35, v32, v32 row_ror:8 row_mask:0xf bank_mask:0x3
    v_add_f32_dpp v35, v33, v33 row_ror:8 row_mask:0xf bank_mask:0xc
    v_add_f32_dpp v36, v34, v34 row_shl:4 row_mask:0xf bank_mask:0x5
    s_nop 0
    v_add_f32_dpp v36, v35, v35 row_shr:4 row_mask:0xf bank_mask:0xa
    v_dot2_f32_bf16 v32, v240, v24, 0
    v_dot2_f32_bf16 v32, v241, v25, v32
    v_dot2_f32_bf16 v32, v242, v26, v32
    v_dot2_f32_bf16 v32, v243, v27, v32
    s_waitcnt vmcnt(7)
    s_cmp_lt_i32 s72, -39
    s_cbranch_scc1 L_f61
    s_waitcnt vmcnt(5)
    s_cmp_lt_i32 s72, -7
    s_cbranch_scc1 L_f61
    s_waitcnt vmcnt(4)
    s_cmp_le_i32 s72, 7
    s_cbranch_scc1 L_f61
    s_waitcnt vmcnt(3)
L_f61:
    buffer_load_dwordx4 v[240:243], v10, s[48:51], s43 offen nt
    s_xor_b32 s43, s27, 512000
    v_dot2_f32_bf16 v33, v244, v24, 0
    v_dot2_f32_bf16 v33, v245, v25, v33
    v_dot2_f32_bf16 v33, v246, v26, v33
    v_dot2_f32_bf16 v33, v247, v27, v33
    s_waitcnt vmcnt(7)
    s_cmp_lt_i32 s72, -55
    s_cbranch_scc1 L_f62
    s_waitcnt vmcnt(5)
    s_cmp_lt_i32 s72, -23
    s_cbranch_scc1 L_f62
    s_waitcnt vmcnt(4)
    s_cmp_le_i32 s72, 23
    s_cbranch_scc1 L_f62
    s_waitcnt vmcnt(3)
L_f62:
    buffer_load_dwordx4 v[244:247], v10, s[48:51], s43 offen nt
    s_xor_b32 s43, s27, 516096
    v_add_f32_dpp v34, v32, v32 row_ror:8 row_mask:0xf bank_mask:0x3
    v_add_f32_dpp v34, v33, v33 row_ror:8 row_mask:0xf bank_mask:0xc
    v_dot2_f32_bf16 v32, v248, v24, 0
    v_dot2_f32_bf16 v32, v249, v25, v32
    v_dot2_f32_bf16 v32, v250, v26, v32
    v_dot2_f32_bf16 v32, v251, v27, v32
    s_waitcnt vmcnt(7)
    s_cmp_lt_i32 s72, -47
    s_cbranch_scc1 L_f63
    s_waitcnt vmcnt(5)
    s_cmp_lt_i32 s72, -15
    s_cbranch_scc1 L_f63
    s_waitcnt vmcnt(4)
    s_cmp_le_i32 s72, 15
    s_cbranch_scc1 L_f63
    s_waitcnt vmcnt(3)
L_f63:
    buffer_load_dwordx4 v[248:251], v10, s[48:51], s43 offen nt
    s_xor_b32 s43, s27, 520192
    v_dot2_f32_bf16 v33, v252, v24, 0
    v_dot2_f32_bf16 v33, v253, v25, v33
    v_dot2_f32_bf16 v33, v254, v26, v33
    v_dot2_f32_bf16 v33, v255, v27, v33
    s_waitcnt vmcnt(7)
    s_cmp_lt_i32 s72, -63
    s_cbranch_scc1 L_f64
    s_waitcnt vmcnt(5)
    s_cmp_lt_i32 s72, -31
    s_cbranch_scc1 L_f64
    s_waitcnt vmcnt(4)
    s_cmp_le_i32 s72, 31
    s_cbranch_scc1 L_f64
    s_waitcnt vmcnt(3)
L_f64:
    buffer_load_dwordx4 v[252:255], v10, s[48:51], s43 offen nt
    s_add_u32 s26, s26, 1
    s_mov_b32 s27, s28
    s_bfe_u32 s8, s26, 0x10000
    s_lshl_b32 s8, s8, 19
    s_or_b32 s27, s27, s8
    s_bfe_u32 s8, s26, 0x10001
    s_lshl_b32 s8, s8, 20
    s_or_b32 s27, s27, s8
    s_bfe_u32 s8, s26, 0x10002
    s_lshl_b32 s8, s8, 22
    s_or_b32 s27, s27, s8
    s_xor_b32 s43, s27, 0
    v_add_f32_dpp v35, v32, v32 row_ror:8 row_mask:0xf bank_mask:0x3
    v_add_f32_dpp v35, v33, v33 row_ror:8 row_mask:0xf bank_mask:0xc
    v_add_f32_dpp v37, v34, v34 row_shl:4 row_mask:0xf bank_mask:0x5
    s_nop 0
    v_add_f32_dpp v37, v35, v35 row_shr:4 row_mask:0xf bank_mask:0xa
    v_add_f32_dpp v40, v36, v36 quad_perm:[2,3,0,1] row_mask:0xf bank_mask:0xf
    s_nop 0
    v_add_f32_dpp v41, v37, v37 quad_perm:[2,3,0,1] row_mask:0xf bank_mask:0xf
    v_cndmask_b32 v39, v40, v41, s[10:11]
    v_add_f32_dpp v40, v38, v38 quad_perm:[1,0,3,2] row_mask:0xf bank_mask:0xf
    s_nop 0
    v_add_f32_dpp v41, v39, v39 quad_perm:[1,0,3,2] row_mask:0xf bank_mask:0xf
    v_cndmask_b32 v43, v40, v41, s[12:13]
    ds_write_b32 v13, v43 offset:13568
    v_max_f32 v28, v28, v43
    ds_read_b32 v64, v12 offset:13312
    ds_read_b32 v65, v12 offset:13568
    ds_read_b32 v66, v12 offset:13824
    ds_read_b32 v67, v12 offset:14080
    ds_read_b32 v68, v12 offset:14336
    ds_read_b32 v69, v12 offset:14592
    ds_read_b32 v70, v12 offset:14848
    ds_read_b32 v71, v12 offset:15104
    ds_read_b32 v72, v12 offset:15360
    ds_read_b32 v73, v12 offset:15616
    ds_read_b32 v74, v12 offset:15872
    ds_read_b32 v75, v12 offset:16128
    ds_read_b32 v76, v12 offset:16384
    ds_read_b32 v77, v12 offset:16640
    ds_read_b32 v78, v12 offset:16896
    ds_read_b32 v79, v12 offset:17152
    v_max_f32_dpp v28, v28, v28 row_ror:8 row_mask:0xf bank_mask:0xf
    s_nop 1
    v_max_f32_dpp v28, v28, v28 row_ror:4 row_mask:0xf bank_mask:0xf
    s_nop 1
    v_max_f32_dpp v28, v28, v28 row_ror:2 row_mask:0xf bank_mask:0xf
    s_nop 1
    v_max_f32_dpp v28, v28, v28 row_ror:1 row_mask:0xf bank_mask:0xf
    v_mov_b32 v44, v28
    s_nop 1
    v_permlane32_swap_b32 v28, v44
    v_max_f32 v28, v28, v44
    v_mov_b32 v44, v28
    s_nop 1
    v_permlane16_swap_b32 v28, v44
    v_max_f32 v28, v28, v44
    v_mul_f32 v44, s14, v28
    s_waitcnt lgkmcnt(0)
    v_fma_f32 v64, v64, s14, -v44
    v_fma_f32 v65, v65, s14, -v44
    v_fma_f32 v66, v66, s14, -v44
    v_fma_f32 v67, v67, s14, -v44
    v_fma_f32 v68, v68, s14, -v44
    v_fma_f32 v69, v69, s14, -v44
    v_fma_f32 v70, v70, s14, -v44
    v_fma_f32 v71, v71, s14, -v44
    v_fma_f32 v72, v72, s14, -v44
    v_fma_f32 v73, v73, s14, -v44
    v_fma_f32 v74, v74, s14, -v44
    v_fma_f32 v75, v75, s14, -v44
    v_fma_f32 v76, v76, s14, -v44
    v_fma_f32 v77, v77, s14, -v44
    v_fma_f32 v78, v78, s14, -v44
    v_fma_f32 v79, v79, s14, -v44
    v_exp_f32 v64, v64
    v_exp_f32 v65, v65
    v_exp_f32 v66, v66
    v_exp_f32 v67, v67
    v_exp_f32 v68, v68
    v_exp_f32 v69, v69
    v_exp_f32 v70, v70
    v_exp_f32 v71, v71
    v_exp_f32 v72, v72
    v_exp_f32 v73, v73
    v_exp_f32 v74, v74
    v_exp_f32 v75, v75
    v_exp_f32 v76, v76
    v_exp_f32 v77, v77
    v_exp_f32 v78, v78
    v_exp_f32 v79, v79
    v_cvt_pk_bf16_f32 v80, v64, 0
    v_cvt_pk_bf16_f32 v81, v65, 0
    v_cvt_pk_bf16_f32 v82, v66, 0
    v_cvt_pk_bf16_f32 v83, v67, 0
    v_cvt_pk_bf16_f32 v84, v68, 0
    v_cvt_pk_bf16_f32 v85, v69, 0
    v_cvt_pk_bf16_f32 v86, v70, 0
    v_cvt_pk_bf16_f32 v87, v71, 0
    v_cvt_pk_bf16_f32 v88, v72, 0
    v_cvt_pk_bf16_f32 v89, v73, 0
    v_cvt_pk_bf16_f32 v90, v74, 0
    v_cvt_pk_bf16_f32 v91, v75, 0
    v_cvt_pk_bf16_f32 v92, v76, 0
    v_cvt_pk_bf16_f32 v93, v77, 0
    v_cvt_pk_bf16_f32 v94, v78, 0
    v_cvt_pk_bf16_f32 v95, v79, 0
    ds_write_b32 v12, v82 offset:13824
    ds_write_b32 v12, v83 offset:14080
    ds_write_b32 v12, v84 offset:14336
    ds_write_b32 v12, v85 offset:14592
    ds_write_b32 v12, v86 offset:14848
    ds_write_b32 v12, v87 offset:15104
    ds_write_b32 v12, v88 offset:15360
    ds_write_b32 v12, v89 offset:15616
    ds_write_b32 v12, v90 offset:15872
    ds_write_b32 v12, v91 offset:16128
    ds_write_b32 v12, v92 offset:16384
    ds_write_b32 v12, v93 offset:16640
    ds_write_b32 v12, v94 offset:16896
    ds_write_b32 v12, v95 offset:17152
    v_add_f32 v64, v64, v72
    v_add_f32 v65, v65, v73
    v_add_f32 v66, v66, v74
    v_add_f32 v67, v67, v75
    v_add_f32 v68, v68, v76
    v_add_f32 v69, v69, v77
    v_add_f32 v70, v70, v78
    v_add_f32 v71, v71, v79
    v_add_f32 v64, v64, v68
    v_add_f32 v65, v65, v69
    v_add_f32 v66, v66, v70
    v_add_f32 v67, v67, v71
    v_add_f32 v64, v64, v66
    v_add_f32 v65, v65, v67
    v_add_f32 v64, v64, v65
    v_mov_b32 v30, v80
    v_mov_b32 v46, v81
    v_add_u32 v13, 512, v12
    v_mov_b32 v16, 0
    v_mov_b32 v17, 0
    v_mov_b32 v18, 0
    v_mov_b32 v19, 0
    v_mov_b32 v20, 0
    v_mov_b32 v21, 0
    v_mov_b32 v22, 0
    v_mov_b32 v23, 0
    v_add_f32_dpp v64, v64, v64 row_ror:8 row_mask:0xf bank_mask:0xf
    s_nop 1
    v_add_f32_dpp v64, v64, v64 row_ror:4 row_mask:0xf bank_mask:0xf
    s_nop 1
    v_add_f32_dpp v64, v64, v64 row_ror:2 row_mask:0xf bank_mask:0xf
    s_nop 1
    v_add_f32_dpp v64, v64, v64 row_ror:1 row_mask:0xf bank_mask:0xf
    v_mov_b32 v44, v64
    s_nop 1
    v_permlane32_swap_b32 v64, v44
    v_add_f32 v64, v64, v44
    v_mov_b32 v44, v64
    s_nop 1
    v_permlane16_swap_b32 v64, v44
    v_add_f32 v64, v64, v44
    v_mov_b32 v29, v64
    v_lshlrev_b32 v44, 1, v9
    s_mov_b64 exec, 1
    ds_write_b64 v44, v[28:29] offset:4608
    ds_add_u32 v1, v45 offset:4664
    s_mov_b64 exec, -1
    s_mov_b32 s15, 7
    s_lshl_b32 s7, s4, 18
    s_lshl_b32 s8, s5, 8
    s_add_u32 s7, s7, s8
    s_add_u32 s52, s24, s7
    s_addc_u32 s53, s25, 0
    s_mov_b32 s54, 260352
    s_mov_b32 s55, 0x20000
    s_add_u32 s56, s34, s7
    s_addc_u32 s57, s35, 0
    s_mov_b32 s58, 260352
    s_mov_b32 s59, 0x20000
    s_lshl_b32 s8, s3, 5
    v_lshl_add_u32 v7, v2, 3, s8
    v_lshlrev_b32 v8, 11, v7
    v_lshl_add_u32 v8, v3, 4, v8
    v_lshrrev_b32 v60, 3, v3
    v_lshl_add_u32 v60, v60, 2, v7
    v_lshlrev_b32 v60, 2, v60
    v_lshl_add_u32 v61, v6, 9, v60
    s_lshl_b32 s18, s4, 12
    s_add_u32 s18, s18, 589824
    s_lshl_b32 s19, s2, 9
    s_add_u32 s19, s19, 589824
    s_lshl_b32 s20, 0x01010101, s5
    s_mov_b32 s21, s20
    s_not_b64 s[22:23], s[20:21]
L_v:
    s_memrealtime s[78:79]
    ds_read_b32 v47, v9 offset:4688
    v_lshlrev_b32 v31, 16, v30
    v_dot2c_f32_bf16_dpp v16, v30, v128 row_newbcast:0 row_mask:0xf bank_mask:0xf
    s_nop 0
    v_dot2c_f32_bf16_dpp v17, v31, v128 row_newbcast:0 row_mask:0xf bank_mask:0xf
    v_dot2c_f32_bf16_dpp v18, v30, v129 row_newbcast:0 row_mask:0xf bank_mask:0xf
    v_dot2c_f32_bf16_dpp v19, v31, v129 row_newbcast:0 row_mask:0xf bank_mask:0xf
    v_dot2c_f32_bf16_dpp v20, v30, v130 row_newbcast:0 row_mask:0xf bank_mask:0xf
    v_dot2c_f32_bf16_dpp v21, v31, v130 row_newbcast:0 row_mask:0xf bank_mask:0xf
    v_dot2c_f32_bf16_dpp v22, v30, v131 row_newbcast:0 row_mask:0xf bank_mask:0xf
    v_dot2c_f32_bf16_dpp v23, v31, v131 row_newbcast:0 row_mask:0xf bank_mask:0xf
    s_waitcnt vmcnt(7)
    s_cmp_lt_i32 s72, -32
    s_cbranch_scc1 L_f65
    s_waitcnt vmcnt(5)
    s_cmp_lt_i32 s72, 0
    s_cbranch_scc1 L_f65
    s_waitcnt vmcnt(4)
    s_cmp_le_i32 s72, 0
    s_cbranch_scc1 L_f65
    s_waitcnt vmcnt(3)
L_f65:
    buffer_load_dwordx4 v[128:131], v10, s[48:51], s43 offen nt
    s_xor_b32 s43, s27, 4096
    s_waitcnt lgkmcnt(0)
    v_readfirstlane_b32 s72, v47
    v_mov_b32 v44, s78
    s_mov_b64 exec, 1
    ds_write_b32 v14, v44 offset:4704
    ds_add_u32 v1, v45 offset:4656
    s_mov_b64 exec, -1
    v_add_u32 v14, 16, v14
    v_dot2c_f32_bf16_dpp v16, v30, v132 row_newbcast:8 row_mask:0xf bank_mask:0xf
    v_dot2c_f32_bf16_dpp v17, v31, v132 row_newbcast:8 row_mask:0xf bank_mask:0xf
    v_dot2c_f32_bf16_dpp v18, v30, v133 row_newbcast:8 row_mask:0xf bank_mask:0xf
    v_dot2c_f32_bf16_dpp v19, v31, v133 row_newbcast:8 row_mask:0xf bank_mask:0xf
    v_dot2c_f32_bf16_dpp v20, v30, v134 row_newbcast:8 row_mask:0xf bank_mask:0xf
    v_dot2c_f32_bf16_dpp v21, v31, v134 row_newbcast:8 row_mask:0xf bank_mask:0xf
    v_dot2c_f32_bf16_dpp v22, v30, v135 row_newbcast:8 row_mask:0xf bank_mask:0xf
    v_dot2c_f32_bf16_dpp v23, v31, v135 row_newbcast:8 row_mask:0xf bank_mask:0xf
    s_waitcnt vmcnt(7)
    s_cmp_lt_i32 s72, -48
    s_cbranch_scc1 L_f66
    s_waitcnt vmcnt(5)
    s_cmp_lt_i32 s72, -16
    s_cbranch_scc1 L_f66
    s_waitcnt vmcnt(4)
    s_cmp_le_i32 s72, 16
    s_cbranch_scc1 L_f66
    s_waitcnt vmcnt(3)
L_f66:
    buffer_load_dwordx4 v[132:135], v10, s[48:51], s43 offen nt
    s_xor_b32 s43, s27, 8192
    v_dot2c_f32_bf16_dpp v16, v30, v136 row_newbcast:4 row_mask:0xf bank_mask:0xf
    v_dot2c_f32_bf16_dpp v17, v31, v136 row_newbcast:4 row_mask:0xf bank_mask:0xf
    v_dot2c_f32_bf16_dpp v18, v30, v137 row_newbcast:4 row_mask:0xf bank_mask:0xf
    v_dot2c_f32_bf16_dpp v19, v31, v137 row_newbcast:4 row_mask:0xf bank_mask:0xf
    v_dot2c_f32_bf16_dpp v20, v30, v138 row_newbcast:4 row_mask:0xf bank_mask:0xf
    v_dot2c_f32_bf16_dpp v21, v31, v138 row_newbcast:4 row_mask:0xf bank_mask:0xf
    v_dot2c_f32_bf16_dpp v22, v30, v139 row_newbcast:4 row_mask:0xf bank_mask:0xf
    v_dot2c_f32_bf16_dpp v23, v31, v139 row_newbcast:4 row_mask:0xf bank_mask:0xf
    s_waitcnt vmcnt(7)
    s_cmp_lt_i32 s72, -40
    s_cbranch_scc1 L_f67
    s_waitcnt vmcnt(5)
    s_cmp_lt_i32 s72, -8
    s_cbranch_scc1 L_f67
    s_waitcnt vmcnt(4)
    s_cmp_le_i32 s72, 8
    s_cbranch_scc1 L_f67
    s_waitcnt vmcnt(3)
L_f67:
    buffer_load_dwordx4 v[136:139], v10, s[48:51], s43 offen nt
    s_xor_b32 s43, s27, 12288
    v_dot2c_f32_bf16_dpp v16, v30, v140 row_newbcast:12 row_mask:0xf bank_mask:0xf
    v_dot2c_f32_bf16_dpp v17, v31, v140 row_newbcast:12 row_mask:0xf bank_mask:0xf
    v_dot2c_f32_bf16_dpp v18, v30, v141 row_newbcast:12 row_mask:0xf bank_mask:0xf
    v_dot2c_f32_bf16_dpp v19, v31, v141 row_newbcast:12 row_mask:0xf bank_mask:0xf
    v_dot2c_f32_bf16_dpp v20, v30, v142 row_newbcast:12 row_mask:0xf bank_mask:0xf
    v_dot2c_f32_bf16_dpp v21, v31, v142 row_newbcast:12 row_mask:0xf bank_mask:0xf
    v_dot2c_f32_bf16_dpp v22, v30, v143 row_newbcast:12 row_mask:0xf bank_mask:0xf
    v_dot2c_f32_bf16_dpp v23, v31, v143 row_newbcast:12 row_mask:0xf bank_mask:0xf
    s_waitcnt vmcnt(7)
    s_cmp_lt_i32 s72, -56
    s_cbranch_scc1 L_f68
    s_waitcnt vmcnt(5)
    s_cmp_lt_i32 s72, -24
    s_cbranch_scc1 L_f68
    s_waitcnt vmcnt(4)
    s_cmp_le_i32 s72, 24
    s_cbranch_scc1 L_f68
    s_waitcnt vmcnt(3)
L_f68:
    buffer_load_dwordx4 v[140:143], v10, s[48:51], s43 offen nt
    s_xor_b32 s43, s27, 49152
    v_dot2c_f32_bf16_dpp v16, v30, v144 row_newbcast:2 row_mask:0xf bank_mask:0xf
    v_dot2c_f32_bf16_dpp v17, v31, v144 row_newbcast:2 row_mask:0xf bank_mask:0xf
    v_dot2c_f32_bf16_dpp v18, v30, v145 row_newbcast:2 row_mask:0xf bank_mask:0xf
    v_dot2c_f32_bf16_dpp v19, v31, v145 row_newbcast:2 row_mask:0xf bank_mask:0xf
    v_dot2c_f32_bf16_dpp v20, v30, v146 row_newbcast:2 row_mask:0xf bank_mask:0xf
    v_dot2c_f32_bf16_dpp v21, v31, v146 row_newbcast:2 row_mask:0xf bank_mask:0xf
    v_dot2c_f32_bf16_dpp v22, v30, v147 row_newbcast:2 row_mask:0xf bank_mask:0xf
    v_dot2c_f32_bf16_dpp v23, v31, v147 row_newbcast:2 row_mask:0xf bank_mask:0xf
    s_waitcnt vmcnt(7)
    s_cmp_lt_i32 s72, -36
    s_cbranch_scc1 L_f69
    s_waitcnt vmcnt(5)
    s_cmp_lt_i32 s72, -4
    s_cbranch_scc1 L_f69
    s_waitcnt vmcnt(4)
    s_cmp_le_i32 s72, 4
    s_cbranch_scc1 L_f69
    s_waitcnt vmcnt(3)
L_f69:
    buffer_load_dwordx4 v[144:147], v10, s[48:51], s43 offen nt
    s_xor_b32 s43, s27, 53248
    v_dot2c_f32_bf16_dpp v16, v30, v148 row_newbcast:10 row_mask:0xf bank_mask:0xf
    v_dot2c_f32_bf16_dpp v17, v31, v148 row_newbcast:10 row_mask:0xf bank_mask:0xf
    v_dot2c_f32_bf16_dpp v18, v30, v149 row_newbcast:10 row_mask:0xf bank_mask:0xf
    v_dot2c_f32_bf16_dpp v19, v31, v149 row_newbcast:10 row_mask:0xf bank_mask:0xf
    v_dot2c_f32_bf16_dpp v20, v30, v150 row_newbcast:10 row_mask:0xf bank_mask:0xf
    v_dot2c_f32_bf16_dpp v21, v31, v150 row_newbcast:10 row_mask:0xf bank_mask:0xf
    v_dot2c_f32_bf16_dpp v22, v30, v151 row_newbcast:10 row_mask:0xf bank_mask:0xf
    v_dot2c_f32_bf16_dpp v23, v31, v151 row_newbcast:10 row_mask:0xf bank_mask:0xf
    s_waitcnt vmcnt(7)
    s_cmp_lt_i32 s72, -52
    s_cbranch_scc1 L_f70
    s_waitcnt vmcnt(5)
    s_cmp_lt_i32 s72, -20
    s_cbranch_scc1 L_f70
    s_waitcnt vmcnt(4)
    s_cmp_le_i32 s72, 20
    s_cbranch_scc1 L_f70
    s_waitcnt vmcnt(3)
L_f70:
    buffer_load_dwordx4 v[148:151], v10, s[48:51], s43 offen nt
    s_xor_b32 s43, s27, 57344
    v_dot2c_f32_bf16_dpp v16, v30, v152 row_newbcast:6 row_mask:0xf bank_mask:0xf
    v_dot2c_f32_bf16_dpp v17, v31, v152 row_newbcast:6 row_mask:0xf bank_mask:0xf
    v_dot2c_f32_bf16_dpp v18, v30, v153 row_newbcast:6 row_mask:0xf bank_mask:0xf
    v_dot2c_f32_bf16_dpp v19, v31, v153 row_newbcast:6 row_mask:0xf bank_mask:0xf
    v_dot2c_f32_bf16_dpp v20, v30, v154 row_newbcast:6 row_mask:0xf bank_mask:0xf
    v_dot2c_f32_bf16_dpp v21, v31, v154 row_newbcast:6 row_mask:0xf bank_mask:0xf
    v_dot2c_f32_bf16_dpp v22, v30, v155 row_newbcast:6 row_mask:0xf bank_mask:0xf
    v_dot2c_f32_bf16_dpp v23, v31, v155 row_newbcast:6 row_mask:0xf bank_mask:0xf
    s_waitcnt vmcnt(7)
    s_cmp_lt_i32 s72, -44
    s_cbranch_scc1 L_f71
    s_waitcnt vmcnt(5)
    s_cmp_lt_i32 s72, -12
    s_cbranch_scc1 L_f71
    s_waitcnt vmcnt(4)
    s_cmp_le_i32 s72, 12
    s_cbranch_scc1 L_f71
    s_waitcnt vmcnt(3)
L_f71:
    buffer_load_dwordx4 v[152:155], v10, s[48:51], s43 offen nt
    s_xor_b32 s43, s27, 61440
    v_dot2c_f32_bf16_dpp v16, v30, v156 row_newbcast:14 row_mask:0xf bank_mask:0xf
    v_dot2c_f32_bf16_dpp v17, v31, v156 row_newbcast:14 row_mask:0xf bank_mask:0xf
    v_dot2c_f32_bf16_dpp v18, v30, v157 row_newbcast:14 row_mask:0xf bank_mask:0xf
    v_dot2c_f32_bf16_dpp v19, v31, v157 row_newbcast:14 row_mask:0xf bank_mask:0xf
    v_dot2c_f32_bf16_dpp v20, v30, v158 row_newbcast:14 row_mask:0xf bank_mask:0xf
    v_dot2c_f32_bf16_dpp v21, v31, v158 row_newbcast:14 row_mask:0xf bank_mask:0xf
    v_dot2c_f32_bf16_dpp v22, v30, v159 row_newbcast:14 row_mask:0xf bank_mask:0xf
    v_dot2c_f32_bf16_dpp v23, v31, v159 row_newbcast:14 row_mask:0xf bank_mask:0xf
    s_waitcnt vmcnt(7)
    s_cmp_lt_i32 s72, -60
    s_cbranch_scc1 L_f72
    s_waitcnt vmcnt(5)
    s_cmp_lt_i32 s72, -28
    s_cbranch_scc1 L_f72
    s_waitcnt vmcnt(4)
    s_cmp_le_i32 s72, 28
    s_cbranch_scc1 L_f72
    s_waitcnt vmcnt(3)
L_f72:
    buffer_load_dwordx4 v[156:159], v10, s[48:51], s43 offen nt
    s_xor_b32 s43, s27, 196608
    ds_read_b32 v47, v9 offset:4688
    v_dot2c_f32_bf16_dpp v16, v30, v160 row_newbcast:1 row_mask:0xf bank_mask:0xf
    v_dot2c_f32_bf16_dpp v17, v31, v160 row_newbcast:1 row_mask:0xf bank_mask:0xf
    v_dot2c_f32_bf16_dpp v18, v30, v161 row_newbcast:1 row_mask:0xf bank_mask:0xf
    v_dot2c_f32_bf16_dpp v19, v31, v161 row_newbcast:1 row_mask:0xf bank_mask:0xf
    v_dot2c_f32_bf16_dpp v20, v30, v162 row_newbcast:1 row_mask:0xf bank_mask:0xf
    v_dot2c_f32_bf16_dpp v21, v31, v162 row_newbcast:1 row_mask:0xf bank_mask:0xf
    v_dot2c_f32_bf16_dpp v22, v30, v163 row_newbcast:1 row_mask:0xf bank_mask:0xf
    v_dot2c_f32_bf16_dpp v23, v31, v163 row_newbcast:1 row_mask:0xf bank_mask:0xf
    s_waitcnt vmcnt(7)
    s_cmp_lt_i32 s72, -34
    s_cbranch_scc1 L_f73
    s_waitcnt vmcnt(5)
    s_cmp_lt_i32 s72, -2
    s_cbranch_scc1 L_f73
    s_waitcnt vmcnt(4)
    s_cmp_le_i32 s72, 2
    s_cbranch_scc1 L_f73
    s_waitcnt vmcnt(3)
L_f73:
    buffer_load_dwordx4 v[160:163], v10, s[48:51], s43 offen nt
    s_xor_b32 s43, s27, 200704
    s_waitcnt lgkmcnt(0)
    v_readfirstlane_b32 s72, v47
    v_dot2c_f32_bf16_dpp v16, v30, v164 row_newbcast:9 row_mask:0xf bank_mask:0xf
    v_dot2c_f32_bf16_dpp v17, v31, v164 row_newbcast:9 row_mask:0xf bank_mask:0xf
    v_dot2c_f32_bf16_dpp v18, v30, v165 row_newbcast:9 row_mask:0xf bank_mask:0xf
    v_dot2c_f32_bf16_dpp v19, v31, v165 row_newbcast:9 row_mask:0xf bank_mask:0xf
    v_dot2c_f32_bf16_dpp v20, v30, v166 row_newbcast:9 row_mask:0xf bank_mask:0xf
    v_dot2c_f32_bf16_dpp v21, v31, v166 row_newbcast:9 row_mask:0xf bank_mask:0xf
    v_dot2c_f32_bf16_dpp v22, v30, v167 row_newbcast:9 row_mask:0xf bank_mask:0xf
    v_dot2c_f32_bf16_dpp v23, v31, v167 row_newbcast:9 row_mask:0xf bank_mask:0xf
    s_waitcnt vmcnt(7)
    s_cmp_lt_i32 s72, -50
    s_cbranch_scc1 L_f74
    s_waitcnt vmcnt(5)
    s_cmp_lt_i32 s72, -18
    s_cbranch_scc1 L_f74
    s_waitcnt vmcnt(4)
    s_cmp_le_i32 s72, 18
    s_cbranch_scc1 L_f74
    s_waitcnt vmcnt(3)
L_f74:
    buffer_load_dwordx4 v[164:167], v10, s[48:51], s43 offen nt
    s_xor_b32 s43, s27, 204800
    v_dot2c_f32_bf16_dpp v16, v30, v168 row_newbcast:5 row_mask:0xf bank_mask:0xf
    v_dot2c_f32_bf16_dpp v17, v31, v168 row_newbcast:5 row_mask:0xf bank_mask:0xf
    v_dot2c_f32_bf16_dpp v18, v30, v169 row_newbcast:5 row_mask:0xf bank_mask:0xf
    v_dot2c_f32_bf16_dpp v19, v31, v169 row_newbcast:5 row_mask:0xf bank_mask:0xf
    v_dot2c_f32_bf16_dpp v20, v30, v170 row_newbcast:5 row_mask:0xf bank_mask:0xf
    v_dot2c_f32_bf16_dpp v21, v31, v170 row_newbcast:5 row_mask:0xf bank_mask:0xf
    v_dot2c_f32_bf16_dpp v22, v30, v171 row_newbcast:5 row_mask:0xf bank_mask:0xf
    v_dot2c_f32_bf16_dpp v23, v31, v171 row_newbcast:5 row_mask:0xf bank_mask:0xf
    s_waitcnt vmcnt(7)
    s_cmp_lt_i32 s72, -42
    s_cbranch_scc1 L_f75
    s_waitcnt vmcnt(5)
    s_cmp_lt_i32 s72, -10
    s_cbranch_scc1 L_f75
    s_waitcnt vmcnt(4)
    s_cmp_le_i32 s72, 10
    s_cbranch_scc1 L_f75
    s_waitcnt vmcnt(3)
L_f75:
    buffer_load_dwordx4 v[168:171], v10, s[48:51], s43 offen nt
    s_xor_b32 s43, s27, 208896
    v_dot2c_f32_bf16_dpp v16, v30, v172 row_newbcast:13 row_mask:0xf bank_mask:0xf
    v_dot2c_f32_bf16_dpp v17, v31, v172 row_newbcast:13 row_mask:0xf bank_mask:0xf
    v_dot2c_f32_bf16_dpp v18, v30, v173 row_newbcast:13 row_mask:0xf bank_mask:0xf
    v_dot2c_f32_bf16_dpp v19, v31, v173 row_newbcast:13 row_mask:0xf bank_mask:0xf
    v_dot2c_f32_bf16_dpp v20, v30, v174 row_newbcast:13 row_mask:0xf bank_mask:0xf
    v_dot2c_f32_bf16_dpp v21, v31, v174 row_newbcast:13 row_mask:0xf bank_mask:0xf
    v_dot2c_f32_bf16_dpp v22, v30, v175 row_newbcast:13 row_mask:0xf bank_mask:0xf
    v_dot2c_f32_bf16_dpp v23, v31, v175 row_newbcast:13 row_mask:0xf bank_mask:0xf
    s_waitcnt vmcnt(7)
    s_cmp_lt_i32 s72, -58
    s_cbranch_scc1 L_f76
    s_waitcnt vmcnt(5)
    s_cmp_lt_i32 s72, -26
    s_cbranch_scc1 L_f76
    s_waitcnt vmcnt(4)
    s_cmp_le_i32 s72, 26
    s_cbranch_scc1 L_f76
    s_waitcnt vmcnt(3)
L_f76:
    buffer_load_dwordx4 v[172:175], v10, s[48:51], s43 offen nt
    s_xor_b32 s43, s27, 245760
    v_dot2c_f32_bf16_dpp v16, v30, v176 row_newbcast:3 row_mask:0xf bank_mask:0xf
    v_dot2c_f32_bf16_dpp v17, v31, v176 row_newbcast:3 row_mask:0xf bank_mask:0xf
    v_dot2c_f32_bf16_dpp v18, v30, v177 row_newbcast:3 row_mask:0xf bank_mask:0xf
    v_dot2c_f32_bf16_dpp v19, v31, v177 row_newbcast:3 row_mask:0xf bank_mask:0xf
    v_dot2c_f32_bf16_dpp v20, v30, v178 row_newbcast:3 row_mask:0xf bank_mask:0xf
    v_dot2c_f32_bf16_dpp v21, v31, v178 row_newbcast:3 row_mask:0xf bank_mask:0xf
    v_dot2c_f32_bf16_dpp v22, v30, v179 row_newbcast:3 row_mask:0xf bank_mask:0xf
    v_dot2c_f32_bf16_dpp v23, v31, v179 row_newbcast:3 row_mask:0xf bank_mask:0xf
    s_waitcnt vmcnt(7)
    s_cmp_lt_i32 s72, -38
    s_cbranch_scc1 L_f77
    s_waitcnt vmcnt(5)
    s_cmp_lt_i32 s72, -6
    s_cbranch_scc1 L_f77
    s_waitcnt vmcnt(4)
    s_cmp_le_i32 s72, 6
    s_cbranch_scc1 L_f77
    s_waitcnt vmcnt(3)
L_f77:
    buffer_load_dwordx4 v[176:179], v10, s[48:51], s43 offen nt
    s_xor_b32 s43, s27, 249856
    v_dot2c_f32_bf16_dpp v16, v30, v180 row_newbcast:11 row_mask:0xf bank_mask:0xf
    v_dot2c_f32_bf16_dpp v17, v31, v180 row_newbcast:11 row_mask:0xf bank_mask:0xf
    v_dot2c_f32_bf16_dpp v18, v30, v181 row_newbcast:11 row_mask:0xf bank_mask:0xf
    v_dot2c_f32_bf16_dpp v19, v31, v181 row_newbcast:11 row_mask:0xf bank_mask:0xf
    v_dot2c_f32_bf16_dpp v20, v30, v182 row_newbcast:11 row_mask:0xf bank_mask:0xf
    v_dot2c_f32_bf16_dpp v21, v31, v182 row_newbcast:11 row_mask:0xf bank_mask:0xf
    v_dot2c_f32_bf16_dpp v22, v30, v183 row_newbcast:11 row_mask:0xf bank_mask:0xf
    v_dot2c_f32_bf16_dpp v23, v31, v183 row_newbcast:11 row_mask:0xf bank_mask:0xf
    s_waitcnt vmcnt(7)
    s_cmp_lt_i32 s72, -54
    s_cbranch_scc1 L_f78
    s_waitcnt vmcnt(5)
    s_cmp_lt_i32 s72, -22
    s_cbranch_scc1 L_f78
    s_waitcnt vmcnt(4)
    s_cmp_le_i32 s72, 22
    s_cbranch_scc1 L_f78
    s_waitcnt vmcnt(3)
L_f78:
    buffer_load_dwordx4 v[180:183], v10, s[48:51], s43 offen nt
    s_xor_b32 s43, s27, 253952
    v_dot2c_f32_bf16_dpp v16, v30, v184 row_newbcast:7 row_mask:0xf bank_mask:0xf
    v_dot2c_f32_bf16_dpp v17, v31, v184 row_newbcast:7 row_mask:0xf bank_mask:0xf
    v_dot2c_f32_bf16_dpp v18, v30, v185 row_newbcast:7 row_mask:0xf bank_mask:0xf
    v_dot2c_f32_bf16_dpp v19, v31, v185 row_newbcast:7 row_mask:0xf bank_mask:0xf
    v_dot2c_f32_bf16_dpp v20, v30, v186 row_newbcast:7 row_mask:0xf bank_mask:0xf
    v_dot2c_f32_bf16_dpp v21, v31, v186 row_newbcast:7 row_mask:0xf bank_mask:0xf
    v_dot2c_f32_bf16_dpp v22, v30, v187 row_newbcast:7 row_mask:0xf bank_mask:0xf
    v_dot2c_f32_bf16_dpp v23, v31, v187 row_newbcast:7 row_mask:0xf bank_mask:0xf
    s_waitcnt vmcnt(7)
    s_cmp_lt_i32 s72, -46
    s_cbranch_scc1 L_f79
    s_waitcnt vmcnt(5)
    s_cmp_lt_i32 s72, -14
    s_cbranch_scc1 L_f79
    s_waitcnt vmcnt(4)
    s_cmp_le_i32 s72, 14
    s_cbranch_scc1 L_f79
    s_waitcnt vmcnt(3)
L_f79:
    buffer_load_dwordx4 v[184:187], v10, s[48:51], s43 offen nt
    s_xor_b32 s43, s27, 258048
    v_dot2c_f32_bf16_dpp v16, v30, v188 row_newbcast:15 row_mask:0xf bank_mask:0xf
    v_dot2c_f32_bf16_dpp v17, v31, v188 row_newbcast:15 row_mask:0xf bank_mask:0xf
    v_dot2c_f32_bf16_dpp v18, v30, v189 row_newbcast:15 row_mask:0xf bank_mask:0xf
    v_dot2c_f32_bf16_dpp v19, v31, v189 row_newbcast:15 row_mask:0xf bank_mask:0xf
    v_dot2c_f32_bf16_dpp v20, v30, v190 row_newbcast:15 row_mask:0xf bank_mask:0xf
    v_dot2c_f32_bf16_dpp v21, v31, v190 row_newbcast:15 row_mask:0xf bank_mask:0xf
    v_dot2c_f32_bf16_dpp v22, v30, v191 row_newbcast:15 row_mask:0xf bank_mask:0xf
    v_dot2c_f32_bf16_dpp v23, v31, v191 row_newbcast:15 row_mask:0xf bank_mask:0xf
    s_waitcnt vmcnt(7)
    s_cmp_lt_i32 s72, -62
    s_cbranch_scc1 L_f80
    s_waitcnt vmcnt(5)
    s_cmp_lt_i32 s72, -30
    s_cbranch_scc1 L_f80
    s_waitcnt vmcnt(4)
    s_cmp_le_i32 s72, 30
    s_cbranch_scc1 L_f80
    s_waitcnt vmcnt(3)
L_f80:
    buffer_load_dwordx4 v[188:191], v10, s[48:51], s43 offen nt
    s_xor_b32 s43, s27, 262144
    ds_read_b32 v47, v9 offset:4688
    s_waitcnt lgkmcnt(0)
    v_mov_b32 v30, v46
    ds_read_b32 v46, v13 offset:13312
    v_lshlrev_b32 v31, 16, v30
    v_dot2c_f32_bf16_dpp v16, v30, v192 row_newbcast:0 row_mask:0xf bank_mask:0xf
    s_nop 0
    v_dot2c_f32_bf16_dpp v17, v31, v192 row_newbcast:0 row_mask:0xf bank_mask:0xf
    v_dot2c_f32_bf16_dpp v18, v30, v193 row_newbcast:0 row_mask:0xf bank_mask:0xf
    v_dot2c_f32_bf16_dpp v19, v31, v193 row_newbcast:0 row_mask:0xf bank_mask:0xf
    v_dot2c_f32_bf16_dpp v20, v30, v194 row_newbcast:0 row_mask:0xf bank_mask:0xf
    v_dot2c_f32_bf16_dpp v21, v31, v194 row_newbcast:0 row_mask:0xf bank_mask:0xf
    v_dot2c_f32_bf16_dpp v22, v30, v195 row_newbcast:0 row_mask:0xf bank_mask:0xf
    v_dot2c_f32_bf16_dpp v23, v31, v195 row_newbcast:0 row_mask:0xf bank_mask:0xf
    s_waitcnt vmcnt(7)
    s_cmp_lt_i32 s72, -33
    s_cbranch_scc1 L_f81
    s_waitcnt vmcnt(5)
    s_cmp_lt_i32 s72, -1
    s_cbranch_scc1 L_f81
    s_waitcnt vmcnt(4)
    s_cmp_le_i32 s72, 1
    s_cbranch_scc1 L_f81
    s_waitcnt vmcnt(3)
L_f81:
    buffer_load_dwordx4 v[192:195], v10, s[48:51], s43 offen nt
    s_xor_b32 s43, s27, 266240
    s_waitcnt lgkmcnt(0)
    v_readfirstlane_b32 s72, v47
    v_dot2c_f32_bf16_dpp v16, v30, v196 row_newbcast:8 row_mask:0xf bank_mask:0xf
    v_dot2c_f32_bf16_dpp v17, v31, v196 row_newbcast:8 row_mask:0xf bank_mask:0xf
    v_dot2c_f32_bf16_dpp v18, v30, v197 row_newbcast:8 row_mask:0xf bank_mask:0xf
    v_dot2c_f32_bf16_dpp v19, v31, v197 row_newbcast:8 row_mask:0xf bank_mask:0xf
    v_dot2c_f32_bf16_dpp v20, v30, v198 row_newbcast:8 row_mask:0xf bank_mask:0xf
    v_dot2c_f32_bf16_dpp v21, v31, v198 row_newbcast:8 row_mask:0xf bank_mask:0xf
    v_dot2c_f32_bf16_dpp v22, v30, v199 row_newbcast:8 row_mask:0xf bank_mask:0xf
    v_dot2c_f32_bf16_dpp v23, v31, v199 row_newbcast:8 row_mask:0xf bank_mask:0xf
    s_waitcnt vmcnt(7)
    s_cmp_lt_i32 s72, -49
    s_cbranch_scc1 L_f82
    s_waitcnt vmcnt(5)
    s_cmp_lt_i32 s72, -17
    s_cbranch_scc1 L_f82
    s_waitcnt vmcnt(4)
    s_cmp_le_i32 s72, 17
    s_cbranch_scc1 L_f82
    s_waitcnt vmcnt(3)
L_f82:
    buffer_load_dwordx4 v[196:199], v10, s[48:51], s43 offen nt
    s_xor_b32 s43, s27, 270336
    v_dot2c_f32_bf16_dpp v16, v30, v200 row_newbcast:4 row_mask:0xf bank_mask:0xf
    v_dot2c_f32_bf16_dpp v17, v31, v200 row_newbcast:4 row_mask:0xf bank_mask:0xf
    v_dot2c_f32_bf16_dpp v18, v30, v201 row_newbcast:4 row_mask:0xf bank_mask:0xf
    v_dot2c_f32_bf16_dpp v19, v31, v201 row_newbcast:4 row_mask:0xf bank_mask:0xf
    v_dot2c_f32_bf16_dpp v20, v30, v202 row_newbcast:4 row_mask:0xf bank_mask:0xf
    v_dot2c_f32_bf16_dpp v21, v31, v202 row_newbcast:4 row_mask:0xf bank_mask:0xf
    v_dot2c_f32_bf16_dpp v22, v30, v203 row_newbcast:4 row_mask:0xf bank_mask:0xf
    v_dot2c_f32_bf16_dpp v23, v31, v203 row_newbcast:4 row_mask:0xf bank_mask:0xf
    s_waitcnt vmcnt(7)
    s_cmp_lt_i32 s72, -41
    s_cbranch_scc1 L_f83
    s_waitcnt vmcnt(5)
    s_cmp_lt_i32 s72, -9
    s_cbranch_scc1 L_f83
    s_waitcnt vmcnt(4)
    s_cmp_le_i32 s72, 9
    s_cbranch_scc1 L_f83
    s_waitcnt vmcnt(3)
L_f83:
    buffer_load_dwordx4 v[200:203], v10, s[48:51], s43 offen nt
    s_xor_b32 s43, s27, 274432
    v_dot2c_f32_bf16_dpp v16, v30, v204 row_newbcast:12 row_mask:0xf bank_mask:0xf
    v_dot2c_f32_bf16_dpp v17, v31, v204 row_newbcast:12 row_mask:0xf bank_mask:0xf
    v_dot2c_f32_bf16_dpp v18, v30, v205 row_newbcast:12 row_mask:0xf bank_mask:0xf
    v_dot2c_f32_bf16_dpp v19, v31, v205 row_newbcast:12 row_mask:0xf bank_mask:0xf
    v_dot2c_f32_bf16_dpp v20, v30, v206 row_newbcast:12 row_mask:0xf bank_mask:0xf
    v_dot2c_f32_bf16_dpp v21, v31, v206 row_newbcast:12 row_mask:0xf bank_mask:0xf
    v_dot2c_f32_bf16_dpp v22, v30, v207 row_newbcast:12 row_mask:0xf bank_mask:0xf
    v_dot2c_f32_bf16_dpp v23, v31, v207 row_newbcast:12 row_mask:0xf bank_mask:0xf
    s_waitcnt vmcnt(7)
    s_cmp_lt_i32 s72, -57
    s_cbranch_scc1 L_f84
    s_waitcnt vmcnt(5)
    s_cmp_lt_i32 s72, -25
    s_cbranch_scc1 L_f84
    s_waitcnt vmcnt(4)
    s_cmp_le_i32 s72, 25
    s_cbranch_scc1 L_f84
    s_waitcnt vmcnt(3)
L_f84:
    buffer_load_dwordx4 v[204:207], v10, s[48:51], s43 offen nt
    s_xor_b32 s43, s27, 311296
    v_dot2c_f32_bf16_dpp v16, v30, v208 row_newbcast:2 row_mask:0xf bank_mask:0xf
    v_dot2c_f32_bf16_dpp v17, v31, v208 row_newbcast:2 row_mask:0xf bank_mask:0xf
    v_dot2c_f32_bf16_dpp v18, v30, v209 row_newbcast:2 row_mask:0xf bank_mask:0xf
    v_dot2c_f32_bf16_dpp v19, v31, v209 row_newbcast:2 row_mask:0xf bank_mask:0xf
    v_dot2c_f32_bf16_dpp v20, v30, v210 row_newbcast:2 row_mask:0xf bank_mask:0xf
    v_dot2c_f32_bf16_dpp v21, v31, v210 row_newbcast:2 row_mask:0xf bank_mask:0xf
    v_dot2c_f32_bf16_dpp v22, v30, v211 row_newbcast:2 row_mask:0xf bank_mask:0xf
    v_dot2c_f32_bf16_dpp v23, v31, v211 row_newbcast:2 row_mask:0xf bank_mask:0xf
    s_waitcnt vmcnt(7)
    s_cmp_lt_i32 s72, -37
    s_cbranch_scc1 L_f85
    s_waitcnt vmcnt(5)
    s_cmp_lt_i32 s72, -5
    s_cbranch_scc1 L_f85
    s_waitcnt vmcnt(4)
    s_cmp_le_i32 s72, 5
    s_cbranch_scc1 L_f85
    s_waitcnt vmcnt(3)
L_f85:
    buffer_load_dwordx4 v[208:211], v10, s[48:51], s43 offen nt
    s_xor_b32 s43, s27, 315392
    v_dot2c_f32_bf16_dpp v16, v30, v212 row_newbcast:10 row_mask:0xf bank_mask:0xf
    v_dot2c_f32_bf16_dpp v17, v31, v212 row_newbcast:10 row_mask:0xf bank_mask:0xf
    v_dot2c_f32_bf16_dpp v18, v30, v213 row_newbcast:10 row_mask:0xf bank_mask:0xf
    v_dot2c_f32_bf16_dpp v19, v31, v213 row_newbcast:10 row_mask:0xf bank_mask:0xf
    v_dot2c_f32_bf16_dpp v20, v30, v214 row_newbcast:10 row_mask:0xf bank_mask:0xf
    v_dot2c_f32_bf16_dpp v21, v31, v214 row_newbcast:10 row_mask:0xf bank_mask:0xf
    v_dot2c_f32_bf16_dpp v22, v30, v215 row_newbcast:10 row_mask:0xf bank_mask:0xf
    v_dot2c_f32_bf16_dpp v23, v31, v215 row_newbcast:10 row_mask:0xf bank_mask:0xf
    s_waitcnt vmcnt(7)
    s_cmp_lt_i32 s72, -53
    s_cbranch_scc1 L_f86
    s_waitcnt vmcnt(5)
    s_cmp_lt_i32 s72, -21
    s_cbranch_scc1 L_f86
    s_waitcnt vmcnt(4)
    s_cmp_le_i32 s72, 21
    s_cbranch_scc1 L_f86
    s_waitcnt vmcnt(3)
L_f86:
    buffer_load_dwordx4 v[212:215], v10, s[48:51], s43 offen nt
    s_xor_b32 s43, s27, 319488
    v_dot2c_f32_bf16_dpp v16, v30, v216 row_newbcast:6 row_mask:0xf bank_mask:0xf
    v_dot2c_f32_bf16_dpp v17, v31, v216 row_newbcast:6 row_mask:0xf bank_mask:0xf
    v_dot2c_f32_bf16_dpp v18, v30, v217 row_newbcast:6 row_mask:0xf bank_mask:0xf
    v_dot2c_f32_bf16_dpp v19, v31, v217 row_newbcast:6 row_mask:0xf bank_mask:0xf
    v_dot2c_f32_bf16_dpp v20, v30, v218 row_newbcast:6 row_mask:0xf bank_mask:0xf
    v_dot2c_f32_bf16_dpp v21, v31, v218 row_newbcast:6 row_mask:0xf bank_mask:0xf
    v_dot2c_f32_bf16_dpp v22, v30, v219 row_newbcast:6 row_mask:0xf bank_mask:0xf
    v_dot2c_f32_bf16_dpp v23, v31, v219 row_newbcast:6 row_mask:0xf bank_mask:0xf
    s_waitcnt vmcnt(7)
    s_cmp_lt_i32 s72, -45
    s_cbranch_scc1 L_f87
    s_waitcnt vmcnt(5)
    s_cmp_lt_i32 s72, -13
    s_cbranch_scc1 L_f87
    s_waitcnt vmcnt(4)
    s_cmp_le_i32 s72, 13
    s_cbranch_scc1 L_f87
    s_waitcnt vmcnt(3)
L_f87:
    buffer_load_dwordx4 v[216:219], v10, s[48:51], s43 offen nt
    s_xor_b32 s43, s27, 323584
    v_dot2c_f32_bf16_dpp v16, v30, v220 row_newbcast:14 row_mask:0xf bank_mask:0xf
    v_dot2c_f32_bf16_dpp v17, v31, v220 row_newbcast:14 row_mask:0xf bank_mask:0xf
    v_dot2c_f32_bf16_dpp v18, v30, v221 row_newbcast:14 row_mask:0xf bank_mask:0xf
    v_dot2c_f32_bf16_dpp v19, v31, v221 row_newbcast:14 row_mask:0xf bank_mask:0xf
    v_dot2c_f32_bf16_dpp v20, v30, v222 row_newbcast:14 row_mask:0xf bank_mask:0xf
    v_dot2c_f32_bf16_dpp v21, v31, v222 row_newbcast:14 row_mask:0xf bank_mask:0xf
    v_dot2c_f32_bf16_dpp v22, v30, v223 row_newbcast:14 row_mask:0xf bank_mask:0xf
    v_dot2c_f32_bf16_dpp v23, v31, v223 row_newbcast:14 row_mask:0xf bank_mask:0xf
    s_waitcnt vmcnt(7)
    s_cmp_lt_i32 s72, -61
    s_cbranch_scc1 L_f88
    s_waitcnt vmcnt(5)
    s_cmp_lt_i32 s72, -29
    s_cbranch_scc1 L_f88
    s_waitcnt vmcnt(4)
    s_cmp_le_i32 s72, 29
    s_cbranch_scc1 L_f88
    s_waitcnt vmcnt(3)
L_f88:
    buffer_load_dwordx4 v[220:223], v10, s[48:51], s43 offen nt
    s_xor_b32 s43, s27, 458752
    ds_read_b32 v47, v9 offset:4688
    v_dot2c_f32_bf16_dpp v16, v30, v224 row_newbcast:1 row_mask:0xf bank_mask:0xf
    v_dot2c_f32_bf16_dpp v17, v31, v224 row_newbcast:1 row_mask:0xf bank_mask:0xf
    v_dot2c_f32_bf16_dpp v18, v30, v225 row_newbcast:1 row_mask:0xf bank_mask:0xf
    v_dot2c_f32_bf16_dpp v19, v31, v225 row_newbcast:1 row_mask:0xf bank_mask:0xf
    v_dot2c_f32_bf16_dpp v20, v30, v226 row_newbcast:1 row_mask:0xf bank_mask:0xf
    v_dot2c_f32_bf16_dpp v21, v31, v226 row_newbcast:1 row_mask:0xf bank_mask:0xf
    v_dot2c_f32_bf16_dpp v22, v30, v227 row_newbcast:1 row_mask:0xf bank_mask:0xf
    v_dot2c_f32_bf16_dpp v23, v31, v227 row_newbcast:1 row_mask:0xf bank_mask:0xf
    s_waitcnt vmcnt(7)
    s_cmp_lt_i32 s72, -35
    s_cbranch_scc1 L_f89
    s_waitcnt vmcnt(5)
    s_cmp_lt_i32 s72, -3
    s_cbranch_scc1 L_f89
    s_waitcnt vmcnt(4)
    s_cmp_le_i32 s72, 3
    s_cbranch_scc1 L_f89
    s_waitcnt vmcnt(3)
L_f89:
    buffer_load_dwordx4 v[224:227], v10, s[48:51], s43 offen nt
    s_xor_b32 s43, s27, 462848
    s_waitcnt lgkmcnt(0)
    v_readfirstlane_b32 s72, v47
    v_dot2c_f32_bf16_dpp v16, v30, v228 row_newbcast:9 row_mask:0xf bank_mask:0xf
    v_dot2c_f32_bf16_dpp v17, v31, v228 row_newbcast:9 row_mask:0xf bank_mask:0xf
    v_dot2c_f32_bf16_dpp v18, v30, v229 row_newbcast:9 row_mask:0xf bank_mask:0xf
    v_dot2c_f32_bf16_dpp v19, v31, v229 row_newbcast:9 row_mask:0xf bank_mask:0xf
    v_dot2c_f32_bf16_dpp v20, v30, v230 row_newbcast:9 row_mask:0xf bank_mask:0xf
    v_dot2c_f32_bf16_dpp v21, v31, v230 row_newbcast:9 row_mask:0xf bank_mask:0xf
    v_dot2c_f32_bf16_dpp v22, v30, v231 row_newbcast:9 row_mask:0xf bank_mask:0xf
    v_dot2c_f32_bf16_dpp v23, v31, v231 row_newbcast:9 row_mask:0xf bank_mask:0xf
    s_waitcnt vmcnt(7)
    s_cmp_lt_i32 s72, -51
    s_cbranch_scc1 L_f90
    s_waitcnt vmcnt(5)
    s_cmp_lt_i32 s72, -19
    s_cbranch_scc1 L_f90
    s_waitcnt vmcnt(4)
    s_cmp_le_i32 s72, 19
    s_cbranch_scc1 L_f90
    s_waitcnt vmcnt(3)
L_f90:
    buffer_load_dwordx4 v[228:231], v10, s[48:51], s43 offen nt
    s_xor_b32 s43, s27, 466944
    v_dot2c_f32_bf16_dpp v16, v30, v232 row_newbcast:5 row_mask:0xf bank_mask:0xf
    v_dot2c_f32_bf16_dpp v17, v31, v232 row_newbcast:5 row_mask:0xf bank_mask:0xf
    v_dot2c_f32_bf16_dpp v18, v30, v233 row_newbcast:5 row_mask:0xf bank_mask:0xf
    v_dot2c_f32_bf16_dpp v19, v31, v233 row_newbcast:5 row_mask:0xf bank_mask:0xf
    v_dot2c_f32_bf16_dpp v20, v30, v234 row_newbcast:5 row_mask:0xf bank_mask:0xf
    v_dot2c_f32_bf16_dpp v21, v31, v234 row_newbcast:5 row_mask:0xf bank_mask:0xf
    v_dot2c_f32_bf16_dpp v22, v30, v235 row_newbcast:5 row_mask:0xf bank_mask:0xf
    v_dot2c_f32_bf16_dpp v23, v31, v235 row_newbcast:5 row_mask:0xf bank_mask:0xf
    s_waitcnt vmcnt(7)
    s_cmp_lt_i32 s72, -43
    s_cbranch_scc1 L_f91
    s_waitcnt vmcnt(5)
    s_cmp_lt_i32 s72, -11
    s_cbranch_scc1 L_f91
    s_waitcnt vmcnt(4)
    s_cmp_le_i32 s72, 11
    s_cbranch_scc1 L_f91
    s_waitcnt vmcnt(3)
L_f91:
    buffer_load_dwordx4 v[232:235], v10, s[48:51], s43 offen nt
    s_xor_b32 s43, s27, 471040
    v_dot2c_f32_bf16_dpp v16, v30, v236 row_newbcast:13 row_mask:0xf bank_mask:0xf
    v_dot2c_f32_bf16_dpp v17, v31, v236 row_newbcast:13 row_mask:0xf bank_mask:0xf
    v_dot2c_f32_bf16_dpp v18, v30, v237 row_newbcast:13 row_mask:0xf bank_mask:0xf
    v_dot2c_f32_bf16_dpp v19, v31, v237 row_newbcast:13 row_mask:0xf bank_mask:0xf
    v_dot2c_f32_bf16_dpp v20, v30, v238 row_newbcast:13 row_mask:0xf bank_mask:0xf
    v_dot2c_f32_bf16_dpp v21, v31, v238 row_newbcast:13 row_mask:0xf bank_mask:0xf
    v_dot2c_f32_bf16_dpp v22, v30, v239 row_newbcast:13 row_mask:0xf bank_mask:0xf
    v_dot2c_f32_bf16_dpp v23, v31, v239 row_newbcast:13 row_mask:0xf bank_mask:0xf
    s_waitcnt vmcnt(7)
    s_cmp_lt_i32 s72, -59
    s_cbranch_scc1 L_f92
    s_waitcnt vmcnt(5)
    s_cmp_lt_i32 s72, -27
    s_cbranch_scc1 L_f92
    s_waitcnt vmcnt(4)
    s_cmp_le_i32 s72, 27
    s_cbranch_scc1 L_f92
    s_waitcnt vmcnt(3)
L_f92:
    buffer_load_dwordx4 v[236:239], v10, s[48:51], s43 offen nt
    s_xor_b32 s43, s27, 507904
    v_dot2c_f32_bf16_dpp v16, v30, v240 row_newbcast:3 row_mask:0xf bank_mask:0xf
    v_dot2c_f32_bf16_dpp v17, v31, v240 row_newbcast:3 row_mask:0xf bank_mask:0xf
    v_dot2c_f32_bf16_dpp v18, v30, v241 row_newbcast:3 row_mask:0xf bank_mask:0xf
    v_dot2c_f32_bf16_dpp v19, v31, v241 row_newbcast:3 row_mask:0xf bank_mask:0xf
    v_dot2c_f32_bf16_dpp v20, v30, v242 row_newbcast:3 row_mask:0xf bank_mask:0xf
    v_dot2c_f32_bf16_dpp v21, v31, v242 row_newbcast:3 row_mask:0xf bank_mask:0xf
    v_dot2c_f32_bf16_dpp v22, v30, v243 row_newbcast:3 row_mask:0xf bank_mask:0xf
    v_dot2c_f32_bf16_dpp v23, v31, v243 row_newbcast:3 row_mask:0xf bank_mask:0xf
    s_waitcnt vmcnt(7)
    s_cmp_lt_i32 s72, -39
    s_cbranch_scc1 L_f93
    s_waitcnt vmcnt(5)
    s_cmp_lt_i32 s72, -7
    s_cbranch_scc1 L_f93
    s_waitcnt vmcnt(4)
    s_cmp_le_i32 s72, 7
    s_cbranch_scc1 L_f93
    s_waitcnt vmcnt(3)
L_f93:
    buffer_load_dwordx4 v[240:243], v10, s[48:51], s43 offen nt
    s_xor_b32 s43, s27, 512000
    v_dot2c_f32_bf16_dpp v16, v30, v244 row_newbcast:11 row_mask:0xf bank_mask:0xf
    v_dot2c_f32_bf16_dpp v17, v31, v244 row_newbcast:11 row_mask:0xf bank_mask:0xf
    v_dot2c_f32_bf16_dpp v18, v30, v245 row_newbcast:11 row_mask:0xf bank_mask:0xf
    v_dot2c_f32_bf16_dpp v19, v31, v245 row_newbcast:11 row_mask:0xf bank_mask:0xf
    v_dot2c_f32_bf16_dpp v20, v30, v246 row_newbcast:11 row_mask:0xf bank_mask:0xf
    v_dot2c_f32_bf16_dpp v21, v31, v246 row_newbcast:11 row_mask:0xf bank_mask:0xf
    v_dot2c_f32_bf16_dpp v22, v30, v247 row_newbcast:11 row_mask:0xf bank_mask:0xf
    v_dot2c_f32_bf16_dpp v23, v31, v247 row_newbcast:11 row_mask:0xf bank_mask:0xf
    s_waitcnt vmcnt(7)
    s_cmp_lt_i32 s72, -55
    s_cbranch_scc1 L_f94
    s_waitcnt vmcnt(5)
    s_cmp_lt_i32 s72, -23
    s_cbranch_scc1 L_f94
    s_waitcnt vmcnt(4)
    s_cmp_le_i32 s72, 23
    s_cbranch_scc1 L_f94
    s_waitcnt vmcnt(3)
L_f94:
    buffer_load_dwordx4 v[244:247], v10, s[48:51], s43 offen nt
    s_xor_b32 s43, s27, 516096
    v_dot2c_f32_bf16_dpp v16, v30, v248 row_newbcast:7 row_mask:0xf bank_mask:0xf
    v_dot2c_f32_bf16_dpp v17, v31, v248 row_newbcast:7 row_mask:0xf bank_mask:0xf
    v_dot2c_f32_bf16_dpp v18, v30, v249 row_newbcast:7 row_mask:0xf bank_mask:0xf
    v_dot2c_f32_bf16_dpp v19, v31, v249 row_newbcast:7 row_mask:0xf bank_mask:0xf
    v_dot2c_f32_bf16_dpp v20, v30, v250 row_newbcast:7 row_mask:0xf bank_mask:0xf
    v_dot2c_f32_bf16_dpp v21, v31, v250 row_newbcast:7 row_mask:0xf bank_mask:0xf
    v_dot2c_f32_bf16_dpp v22, v30, v251 row_newbcast:7 row_mask:0xf bank_mask:0xf
    v_dot2c_f32_bf16_dpp v23, v31, v251 row_newbcast:7 row_mask:0xf bank_mask:0xf
    s_waitcnt vmcnt(7)
    s_cmp_lt_i32 s72, -47
    s_cbranch_scc1 L_f95
    s_waitcnt vmcnt(5)
    s_cmp_lt_i32 s72, -15
    s_cbranch_scc1 L_f95
    s_waitcnt vmcnt(4)
    s_cmp_le_i32 s72, 15
    s_cbranch_scc1 L_f95
    s_waitcnt vmcnt(3)
L_f95:
    buffer_load_dwordx4 v[248:251], v10, s[48:51], s43 offen nt
    s_xor_b32 s43, s27, 520192
    v_dot2c_f32_bf16_dpp v16, v30, v252 row_newbcast:15 row_mask:0xf bank_mask:0xf
    v_dot2c_f32_bf16_dpp v17, v31, v252 row_newbcast:15 row_mask:0xf bank_mask:0xf
    v_dot2c_f32_bf16_dpp v18, v30, v253 row_newbcast:15 row_mask:0xf bank_mask:0xf
    v_dot2c_f32_bf16_dpp v19, v31, v253 row_newbcast:15 row_mask:0xf bank_mask:0xf
    v_dot2c_f32_bf16_dpp v20, v30, v254 row_newbcast:15 row_mask:0xf bank_mask:0xf
    v_dot2c_f32_bf16_dpp v21, v31, v254 row_newbcast:15 row_mask:0xf bank_mask:0xf
    v_dot2c_f32_bf16_dpp v22, v30, v255 row_newbcast:15 row_mask:0xf bank_mask:0xf
    v_dot2c_f32_bf16_dpp v23, v31, v255 row_newbcast:15 row_mask:0xf bank_mask:0xf
    s_waitcnt vmcnt(7)
    s_cmp_lt_i32 s72, -63
    s_cbranch_scc1 L_f96
    s_waitcnt vmcnt(5)
    s_cmp_lt_i32 s72, -31
    s_cbranch_scc1 L_f96
    s_waitcnt vmcnt(4)
    s_cmp_le_i32 s72, 31
    s_cbranch_scc1 L_f96
    s_waitcnt vmcnt(3)
L_f96:
    buffer_load_dwordx4 v[252:255], v10, s[48:51], s43 offen nt
    s_add_u32 s26, s26, 1
    s_mov_b32 s27, s28
    s_bfe_u32 s8, s26, 0x10000
    s_lshl_b32 s8, s8, 19
    s_or_b32 s27, s27, s8
    s_bfe_u32 s8, s26, 0x10001
    s_lshl_b32 s8, s8, 20
    s_or_b32 s27, s27, s8
    s_bfe_u32 s8, s26, 0x10002
    s_lshl_b32 s8, s8, 22
    s_or_b32 s27, s27, s8
    s_xor_b32 s43, s27, 0
    s_waitcnt lgkmcnt(0)
    v_mov_b32 v30, v46
    ds_read_b32 v46, v13 offset:13568
    v_add_u32 v13, 512, v13
    s_sub_u32 s15, s15, 1
    s_cmp_lg_u32 s15, 0
    s_cbranch_scc1 L_v
    v_lshlrev_b32 v31, 16, v30
    v_dot2c_f32_bf16_dpp v16, v30, v128 row_newbcast:0 row_mask:0xf bank_mask:0xf
    s_nop 0
    v_dot2c_f32_bf16_dpp v17, v31, v128 row_newbcast:0 row_mask:0xf bank_mask:0xf
    v_dot2c_f32_bf16_dpp v18, v30, v129 row_newbcast:0 row_mask:0xf bank_mask:0xf
    v_dot2c_f32_bf16_dpp v19, v31, v129 row_newbcast:0 row_mask:0xf bank_mask:0xf
    v_dot2c_f32_bf16_dpp v20, v30, v130 row_newbcast:0 row_mask:0xf bank_mask:0xf
    v_dot2c_f32_bf16_dpp v21, v31, v130 row_newbcast:0 row_mask:0xf bank_mask:0xf
    v_dot2c_f32_bf16_dpp v22, v30, v131 row_newbcast:0 row_mask:0xf bank_mask:0xf
    v_dot2c_f32_bf16_dpp v23, v31, v131 row_newbcast:0 row_mask:0xf bank_mask:0xf
    v_dot2c_f32_bf16_dpp v16, v30, v132 row_newbcast:8 row_mask:0xf bank_mask:0xf
    v_dot2c_f32_bf16_dpp v17, v31, v132 row_newbcast:8 row_mask:0xf bank_mask:0xf
    v_dot2c_f32_bf16_dpp v18, v30, v133 row_newbcast:8 row_mask:0xf bank_mask:0xf
    v_dot2c_f32_bf16_dpp v19, v31, v133 row_newbcast:8 row_mask:0xf bank_mask:0xf
    v_dot2c_f32_bf16_dpp v20, v30, v134 row_newbcast:8 row_mask:0xf bank_mask:0xf
    v_dot2c_f32_bf16_dpp v21, v31, v134 row_newbcast:8 row_mask:0xf bank_mask:0xf
    v_dot2c_f32_bf16_dpp v22, v30, v135 row_newbcast:8 row_mask:0xf bank_mask:0xf
    v_dot2c_f32_bf16_dpp v23, v31, v135 row_newbcast:8 row_mask:0xf bank_mask:0xf
    s_mov_b32 s73, 0
    s_waitcnt vmcnt(6)
    buffer_load_dwordx4 v[96:99], v8, s[56:59], s73 offen offset:0 nt
    v_dot2c_f32_bf16_dpp v16, v30, v136 row_newbcast:4 row_mask:0xf bank_mask:0xf
    v_dot2c_f32_bf16_dpp v17, v31, v136 row_newbcast:4 row_mask:0xf bank_mask:0xf
    v_dot2c_f32_bf16_dpp v18, v30, v137 row_newbcast:4 row_mask:0xf bank_mask:0xf
    v_dot2c_f32_bf16_dpp v19, v31, v137 row_newbcast:4 row_mask:0xf bank_mask:0xf
    v_dot2c_f32_bf16_dpp v20, v30, v138 row_newbcast:4 row_mask:0xf bank_mask:0xf
    v_dot2c_f32_bf16_dpp v21, v31, v138 row_newbcast:4 row_mask:0xf bank_mask:0xf
    v_dot2c_f32_bf16_dpp v22, v30, v139 row_newbcast:4 row_mask:0xf bank_mask:0xf
    v_dot2c_f32_bf16_dpp v23, v31, v139 row_newbcast:4 row_mask:0xf bank_mask:0xf
    v_dot2c_f32_bf16_dpp v16, v30, v140 row_newbcast:12 row_mask:0xf bank_mask:0xf
    v_dot2c_f32_bf16_dpp v17, v31, v140 row_newbcast:12 row_mask:0xf bank_mask:0xf
    v_dot2c_f32_bf16_dpp v18, v30, v141 row_newbcast:12 row_mask:0xf bank_mask:0xf
    v_dot2c_f32_bf16_dpp v19, v31, v141 row_newbcast:12 row_mask:0xf bank_mask:0xf
    v_dot2c_f32_bf16_dpp v20, v30, v142 row_newbcast:12 row_mask:0xf bank_mask:0xf
    v_dot2c_f32_bf16_dpp v21, v31, v142 row_newbcast:12 row_mask:0xf bank_mask:0xf
    v_dot2c_f32_bf16_dpp v22, v30, v143 row_newbcast:12 row_mask:0xf bank_mask:0xf
    v_dot2c_f32_bf16_dpp v23, v31, v143 row_newbcast:12 row_mask:0xf bank_mask:0xf
    v_dot2c_f32_bf16_dpp v16, v30, v144 row_newbcast:2 row_mask:0xf bank_mask:0xf
    v_dot2c_f32_bf16_dpp v17, v31, v144 row_newbcast:2 row_mask:0xf bank_mask:0xf
    v_dot2c_f32_bf16_dpp v18, v30, v145 row_newbcast:2 row_mask:0xf bank_mask:0xf
    v_dot2c_f32_bf16_dpp v19, v31, v145 row_newbcast:2 row_mask:0xf bank_mask:0xf
    v_dot2c_f32_bf16_dpp v20, v30, v146 row_newbcast:2 row_mask:0xf bank_mask:0xf
    v_dot2c_f32_bf16_dpp v21, v31, v146 row_newbcast:2 row_mask:0xf bank_mask:0xf
    v_dot2c_f32_bf16_dpp v22, v30, v147 row_newbcast:2 row_mask:0xf bank_mask:0xf
    v_dot2c_f32_bf16_dpp v23, v31, v147 row_newbcast:2 row_mask:0xf bank_mask:0xf
    v_dot2c_f32_bf16_dpp v16, v30, v148 row_newbcast:10 row_mask:0xf bank_mask:0xf
    v_dot2c_f32_bf16_dpp v17, v31, v148 row_newbcast:10 row_mask:0xf bank_mask:0xf
    v_dot2c_f32_bf16_dpp v18, v30, v149 row_newbcast:10 row_mask:0xf bank_mask:0xf
    v_dot2c_f32_bf16_dpp v19, v31, v149 row_newbcast:10 row_mask:0xf bank_mask:0xf
    v_dot2c_f32_bf16_dpp v20, v30, v150 row_newbcast:10 row_mask:0xf bank_mask:0xf
    v_dot2c_f32_bf16_dpp v21, v31, v150 row_newbcast:10 row_mask:0xf bank_mask:0xf
    v_dot2c_f32_bf16_dpp v22, v30, v151 row_newbcast:10 row_mask:0xf bank_mask:0xf
    v_dot2c_f32_bf16_dpp v23, v31, v151 row_newbcast:10 row_mask:0xf bank_mask:0xf
    v_dot2c_f32_bf16_dpp v16, v30, v152 row_newbcast:6 row_mask:0xf bank_mask:0xf
    v_dot2c_f32_bf16_dpp v17, v31, v152 row_newbcast:6 row_mask:0xf bank_mask:0xf
    v_dot2c_f32_bf16_dpp v18, v30, v153 row_newbcast:6 row_mask:0xf bank_mask:0xf
    v_dot2c_f32_bf16_dpp v19, v31, v153 row_newbcast:6 row_mask:0xf bank_mask:0xf
    v_dot2c_f32_bf16_dpp v20, v30, v154 row_newbcast:6 row_mask:0xf bank_mask:0xf
    v_dot2c_f32_bf16_dpp v21, v31, v154 row_newbcast:6 row_mask:0xf bank_mask:0xf
    v_dot2c_f32_bf16_dpp v22, v30, v155 row_newbcast:6 row_mask:0xf bank_mask:0xf
    v_dot2c_f32_bf16_dpp v23, v31, v155 row_newbcast:6 row_mask:0xf bank_mask:0xf
    v_dot2c_f32_bf16_dpp v16, v30, v156 row_newbcast:14 row_mask:0xf bank_mask:0xf
    v_dot2c_f32_bf16_dpp v17, v31, v156 row_newbcast:14 row_mask:0xf bank_mask:0xf
    v_dot2c_f32_bf16_dpp v18, v30, v157 row_newbcast:14 row_mask:0xf bank_mask:0xf
    v_dot2c_f32_bf16_dpp v19, v31, v157 row_newbcast:14 row_mask:0xf bank_mask:0xf
    v_dot2c_f32_bf16_dpp v20, v30, v158 row_newbcast:14 row_mask:0xf bank_mask:0xf
    v_dot2c_f32_bf16_dpp v21, v31, v158 row_newbcast:14 row_mask:0xf bank_mask:0xf
    v_dot2c_f32_bf16_dpp v22, v30, v159 row_newbcast:14 row_mask:0xf bank_mask:0xf
    v_dot2c_f32_bf16_dpp v23, v31, v159 row_newbcast:14 row_mask:0xf bank_mask:0xf
    v_dot2c_f32_bf16_dpp v16, v30, v160 row_newbcast:1 row_mask:0xf bank_mask:0xf
    v_dot2c_f32_bf16_dpp v17, v31, v160 row_newbcast:1 row_mask:0xf bank_mask:0xf
    v_dot2c_f32_bf16_dpp v18, v30, v161 row_newbcast:1 row_mask:0xf bank_mask:0xf
    v_dot2c_f32_bf16_dpp v19, v31, v161 row_newbcast:1 row_mask:0xf bank_mask:0xf
    v_dot2c_f32_bf16_dpp v20, v30, v162 row_newbcast:1 row_mask:0xf bank_mask:0xf
    v_dot2c_f32_bf16_dpp v21, v31, v162 row_newbcast:1 row_mask:0xf bank_mask:0xf
    v_dot2c_f32_bf16_dpp v22, v30, v163 row_newbcast:1 row_mask:0xf bank_mask:0xf
    v_dot2c_f32_bf16_dpp v23, v31, v163 row_newbcast:1 row_mask:0xf bank_mask:0xf
    v_dot2c_f32_bf16_dpp v16, v30, v164 row_newbcast:9 row_mask:0xf bank_mask:0xf
    v_dot2c_f32_bf16_dpp v17, v31, v164 row_newbcast:9 row_mask:0xf bank_mask:0xf
    v_dot2c_f32_bf16_dpp v18, v30, v165 row_newbcast:9 row_mask:0xf bank_mask:0xf
    v_dot2c_f32_bf16_dpp v19, v31, v165 row_newbcast:9 row_mask:0xf bank_mask:0xf
    v_dot2c_f32_bf16_dpp v20, v30, v166 row_newbcast:9 row_mask:0xf bank_mask:0xf
    v_dot2c_f32_bf16_dpp v21, v31, v166 row_newbcast:9 row_mask:0xf bank_mask:0xf
    v_dot2c_f32_bf16_dpp v22, v30, v167 row_newbcast:9 row_mask:0xf bank_mask:0xf
    v_dot2c_f32_bf16_dpp v23, v31, v167 row_newbcast:9 row_mask:0xf bank_mask:0xf
    s_waitcnt vmcnt(6)
    buffer_load_dwordx4 v[100:103], v8, s[56:59], s73 offen offset:2048 nt
    s_add_u32 s73, s73, 4096
    v_dot2c_f32_bf16_dpp v16, v30, v168 row_newbcast:5 row_mask:0xf bank_mask:0xf
    v_dot2c_f32_bf16_dpp v17, v31, v168 row_newbcast:5 row_mask:0xf bank_mask:0xf
    v_dot2c_f32_bf16_dpp v18, v30, v169 row_newbcast:5 row_mask:0xf bank_mask:0xf
    v_dot2c_f32_bf16_dpp v19, v31, v169 row_newbcast:5 row_mask:0xf bank_mask:0xf
    v_dot2c_f32_bf16_dpp v20, v30, v170 row_newbcast:5 row_mask:0xf bank_mask:0xf
    v_dot2c_f32_bf16_dpp v21, v31, v170 row_newbcast:5 row_mask:0xf bank_mask:0xf
    v_dot2c_f32_bf16_dpp v22, v30, v171 row_newbcast:5 row_mask:0xf bank_mask:0xf
    v_dot2c_f32_bf16_dpp v23, v31, v171 row_newbcast:5 row_mask:0xf bank_mask:0xf
    v_dot2c_f32_bf16_dpp v16, v30, v172 row_newbcast:13 row_mask:0xf bank_mask:0xf
    v_dot2c_f32_bf16_dpp v17, v31, v172 row_newbcast:13 row_mask:0xf bank_mask:0xf
    v_dot2c_f32_bf16_dpp v18, v30, v173 row_newbcast:13 row_mask:0xf bank_mask:0xf
    v_dot2c_f32_bf16_dpp v19, v31, v173 row_newbcast:13 row_mask:0xf bank_mask:0xf
    v_dot2c_f32_bf16_dpp v20, v30, v174 row_newbcast:13 row_mask:0xf bank_mask:0xf
    v_dot2c_f32_bf16_dpp v21, v31, v174 row_newbcast:13 row_mask:0xf bank_mask:0xf
    v_dot2c_f32_bf16_dpp v22, v30, v175 row_newbcast:13 row_mask:0xf bank_mask:0xf
    v_dot2c_f32_bf16_dpp v23, v31, v175 row_newbcast:13 row_mask:0xf bank_mask:0xf
    v_dot2c_f32_bf16_dpp v16, v30, v176 row_newbcast:3 row_mask:0xf bank_mask:0xf
    v_dot2c_f32_bf16_dpp v17, v31, v176 row_newbcast:3 row_mask:0xf bank_mask:0xf
    v_dot2c_f32_bf16_dpp v18, v30, v177 row_newbcast:3 row_mask:0xf bank_mask:0xf
    v_dot2c_f32_bf16_dpp v19, v31, v177 row_newbcast:3 row_mask:0xf bank_mask:0xf
    v_dot2c_f32_bf16_dpp v20, v30, v178 row_newbcast:3 row_mask:0xf bank_mask:0xf
    v_dot2c_f32_bf16_dpp v21, v31, v178 row_newbcast:3 row_mask:0xf bank_mask:0xf
    v_dot2c_f32_bf16_dpp v22, v30, v179 row_newbcast:3 row_mask:0xf bank_mask:0xf
    v_dot2c_f32_bf16_dpp v23, v31, v179 row_newbcast:3 row_mask:0xf bank_mask:0xf
    v_dot2c_f32_bf16_dpp v16, v30, v180 row_newbcast:11 row_mask:0xf bank_mask:0xf
    v_dot2c_f32_bf16_dpp v17, v31, v180 row_newbcast:11 row_mask:0xf bank_mask:0xf
    v_dot2c_f32_bf16_dpp v18, v30, v181 row_newbcast:11 row_mask:0xf bank_mask:0xf
    v_dot2c_f32_bf16_dpp v19, v31, v181 row_newbcast:11 row_mask:0xf bank_mask:0xf
    v_dot2c_f32_bf16_dpp v20, v30, v182 row_newbcast:11 row_mask:0xf bank_mask:0xf
    v_dot2c_f32_bf16_dpp v21, v31, v182 row_newbcast:11 row_mask:0xf bank_mask:0xf
    v_dot2c_f32_bf16_dpp v22, v30, v183 row_newbcast:11 row_mask:0xf bank_mask:0xf
    v_dot2c_f32_bf16_dpp v23, v31, v183 row_newbcast:11 row_mask:0xf bank_mask:0xf
    v_dot2c_f32_bf16_dpp v16, v30, v184 row_newbcast:7 row_mask:0xf bank_mask:0xf
    v_dot2c_f32_bf16_dpp v17, v31, v184 row_newbcast:7 row_mask:0xf bank_mask:0xf
    v_dot2c_f32_bf16_dpp v18, v30, v185 row_newbcast:7 row_mask:0xf bank_mask:0xf
    v_dot2c_f32_bf16_dpp v19, v31, v185 row_newbcast:7 row_mask:0xf bank_mask:0xf
    v_dot2c_f32_bf16_dpp v20, v30, v186 row_newbcast:7 row_mask:0xf bank_mask:0xf
    v_dot2c_f32_bf16_dpp v21, v31, v186 row_newbcast:7 row_mask:0xf bank_mask:0xf
    v_dot2c_f32_bf16_dpp v22, v30, v187 row_newbcast:7 row_mask:0xf bank_mask:0xf
    v_dot2c_f32_bf16_dpp v23, v31, v187 row_newbcast:7 row_mask:0xf bank_mask:0xf
    v_dot2c_f32_bf16_dpp v16, v30, v188 row_newbcast:15 row_mask:0xf bank_mask:0xf
    v_dot2c_f32_bf16_dpp v17, v31, v188 row_newbcast:15 row_mask:0xf bank_mask:0xf
    v_dot2c_f32_bf16_dpp v18, v30, v189 row_newbcast:15 row_mask:0xf bank_mask:0xf
    v_dot2c_f32_bf16_dpp v19, v31, v189 row_newbcast:15 row_mask:0xf bank_mask:0xf
    v_dot2c_f32_bf16_dpp v20, v30, v190 row_newbcast:15 row_mask:0xf bank_mask:0xf
    v_dot2c_f32_bf16_dpp v21, v31, v190 row_newbcast:15 row_mask:0xf bank_mask:0xf
    v_dot2c_f32_bf16_dpp v22, v30, v191 row_newbcast:15 row_mask:0xf bank_mask:0xf
    v_dot2c_f32_bf16_dpp v23, v31, v191 row_newbcast:15 row_mask:0xf bank_mask:0xf
    s_waitcnt lgkmcnt(0)
    v_mov_b32 v30, v46
    v_lshlrev_b32 v31, 16, v30
    s_nop 0
    v_dot2c_f32_bf16_dpp v16, v30, v192 row_newbcast:0 row_mask:0xf bank_mask:0xf
    v_dot2c_f32_bf16_dpp v17, v31, v192 row_newbcast:0 row_mask:0xf bank_mask:0xf
    v_dot2c_f32_bf16_dpp v18, v30, v193 row_newbcast:0 row_mask:0xf bank_mask:0xf
    v_dot2c_f32_bf16_dpp v19, v31, v193 row_newbcast:0 row_mask:0xf bank_mask:0xf
    v_dot2c_f32_bf16_dpp v20, v30, v194 row_newbcast:0 row_mask:0xf bank_mask:0xf
    v_dot2c_f32_bf16_dpp v21, v31, v194 row_newbcast:0 row_mask:0xf bank_mask:0xf
    v_dot2c_f32_bf16_dpp v22, v30, v195 row_newbcast:0 row_mask:0xf bank_mask:0xf
    v_dot2c_f32_bf16_dpp v23, v31, v195 row_newbcast:0 row_mask:0xf bank_mask:0xf
    v_dot2c_f32_bf16_dpp v16, v30, v196 row_newbcast:8 row_mask:0xf bank_mask:0xf
    v_dot2c_f32_bf16_dpp v17, v31, v196 row_newbcast:8 row_mask:0xf bank_mask:0xf
    v_dot2c_f32_bf16_dpp v18, v30, v197 row_newbcast:8 row_mask:0xf bank_mask:0xf
    v_dot2c_f32_bf16_dpp v19, v31, v197 row_newbcast:8 row_mask:0xf bank_mask:0xf
    v_dot2c_f32_bf16_dpp v20, v30, v198 row_newbcast:8 row_mask:0xf bank_mask:0xf
    v_dot2c_f32_bf16_dpp v21, v31, v198 row_newbcast:8 row_mask:0xf bank_mask:0xf
    v_dot2c_f32_bf16_dpp v22, v30, v199 row_newbcast:8 row_mask:0xf bank_mask:0xf
    v_dot2c_f32_bf16_dpp v23, v31, v199 row_newbcast:8 row_mask:0xf bank_mask:0xf
    v_dot2c_f32_bf16_dpp v16, v30, v200 row_newbcast:4 row_mask:0xf bank_mask:0xf
    v_dot2c_f32_bf16_dpp v17, v31, v200 row_newbcast:4 row_mask:0xf bank_mask:0xf
    v_dot2c_f32_bf16_dpp v18, v30, v201 row_newbcast:4 row_mask:0xf bank_mask:0xf
    v_dot2c_f32_bf16_dpp v19, v31, v201 row_newbcast:4 row_mask:0xf bank_mask:0xf
    v_dot2c_f32_bf16_dpp v20, v30, v202 row_newbcast:4 row_mask:0xf bank_mask:0xf
    v_dot2c_f32_bf16_dpp v21, v31, v202 row_newbcast:4 row_mask:0xf bank_mask:0xf
    v_dot2c_f32_bf16_dpp v22, v30, v203 row_newbcast:4 row_mask:0xf bank_mask:0xf
    v_dot2c_f32_bf16_dpp v23, v31, v203 row_newbcast:4 row_mask:0xf bank_mask:0xf
    v_dot2c_f32_bf16_dpp v16, v30, v204 row_newbcast:12 row_mask:0xf bank_mask:0xf
    v_dot2c_f32_bf16_dpp v17, v31, v204 row_newbcast:12 row_mask:0xf bank_mask:0xf
    v_dot2c_f32_bf16_dpp v18, v30, v205 row_newbcast:12 row_mask:0xf bank_mask:0xf
    v_dot2c_f32_bf16_dpp v19, v31, v205 row_newbcast:12 row_mask:0xf bank_mask:0xf
    v_dot2c_f32_bf16_dpp v20, v30, v206 row_newbcast:12 row_mask:0xf bank_mask:0xf
    v_dot2c_f32_bf16_dpp v21, v31, v206 row_newbcast:12 row_mask:0xf bank_mask:0xf
    v_dot2c_f32_bf16_dpp v22, v30, v207 row_newbcast:12 row_mask:0xf bank_mask:0xf
    v_dot2c_f32_bf16_dpp v23, v31, v207 row_newbcast:12 row_mask:0xf bank_mask:0xf
    s_waitcnt vmcnt(6)
    buffer_load_dwordx4 v[104:107], v8, s[56:59], s73 offen offset:0 nt
    v_dot2c_f32_bf16_dpp v16, v30, v208 row_newbcast:2 row_mask:0xf bank_mask:0xf
    v_dot2c_f32_bf16_dpp v17, v31, v208 row_newbcast:2 row_mask:0xf bank_mask:0xf
    v_dot2c_f32_bf16_dpp v18, v30, v209 row_newbcast:2 row_mask:0xf bank_mask:0xf
    v_dot2c_f32_bf16_dpp v19, v31, v209 row_newbcast:2 row_mask:0xf bank_mask:0xf
    v_dot2c_f32_bf16_dpp v20, v30, v210 row_newbcast:2 row_mask:0xf bank_mask:0xf
    v_dot2c_f32_bf16_dpp v21, v31, v210 row_newbcast:2 row_mask:0xf bank_mask:0xf
    v_dot2c_f32_bf16_dpp v22, v30, v211 row_newbcast:2 row_mask:0xf bank_mask:0xf
    v_dot2c_f32_bf16_dpp v23, v31, v211 row_newbcast:2 row_mask:0xf bank_mask:0xf
    v_dot2c_f32_bf16_dpp v16, v30, v212 row_newbcast:10 row_mask:0xf bank_mask:0xf
    v_dot2c_f32_bf16_dpp v17, v31, v212 row_newbcast:10 row_mask:0xf bank_mask:0xf
    v_dot2c_f32_bf16_dpp v18, v30, v213 row_newbcast:10 row_mask:0xf bank_mask:0xf
    v_dot2c_f32_bf16_dpp v19, v31, v213 row_newbcast:10 row_mask:0xf bank_mask:0xf
    v_dot2c_f32_bf16_dpp v20, v30, v214 row_newbcast:10 row_mask:0xf bank_mask:0xf
    v_dot2c_f32_bf16_dpp v21, v31, v214 row_newbcast:10 row_mask:0xf bank_mask:0xf
    v_dot2c_f32_bf16_dpp v22, v30, v215 row_newbcast:10 row_mask:0xf bank_mask:0xf
    v_dot2c_f32_bf16_dpp v23, v31, v215 row_newbcast:10 row_mask:0xf bank_mask:0xf
    v_dot2c_f32_bf16_dpp v16, v30, v216 row_newbcast:6 row_mask:0xf bank_mask:0xf
    v_dot2c_f32_bf16_dpp v17, v31, v216 row_newbcast:6 row_mask:0xf bank_mask:0xf
    v_dot2c_f32_bf16_dpp v18, v30, v217 row_newbcast:6 row_mask:0xf bank_mask:0xf
    v_dot2c_f32_bf16_dpp v19, v31, v217 row_newbcast:6 row_mask:0xf bank_mask:0xf
    v_dot2c_f32_bf16_dpp v20, v30, v218 row_newbcast:6 row_mask:0xf bank_mask:0xf
    v_dot2c_f32_bf16_dpp v21, v31, v218 row_newbcast:6 row_mask:0xf bank_mask:0xf
    v_dot2c_f32_bf16_dpp v22, v30, v219 row_newbcast:6 row_mask:0xf bank_mask:0xf
    v_dot2c_f32_bf16_dpp v23, v31, v219 row_newbcast:6 row_mask:0xf bank_mask:0xf
    v_dot2c_f32_bf16_dpp v16, v30, v220 row_newbcast:14 row_mask:0xf bank_mask:0xf
    v_dot2c_f32_bf16_dpp v17, v31, v220 row_newbcast:14 row_mask:0xf bank_mask:0xf
    v_dot2c_f32_bf16_dpp v18, v30, v221 row_newbcast:14 row_mask:0xf bank_mask:0xf
    v_dot2c_f32_bf16_dpp v19, v31, v221 row_newbcast:14 row_mask:0xf bank_mask:0xf
    v_dot2c_f32_bf16_dpp v20, v30, v222 row_newbcast:14 row_mask:0xf bank_mask:0xf
    v_dot2c_f32_bf16_dpp v21, v31, v222 row_newbcast:14 row_mask:0xf bank_mask:0xf
    v_dot2c_f32_bf16_dpp v22, v30, v223 row_newbcast:14 row_mask:0xf bank_mask:0xf
    v_dot2c_f32_bf16_dpp v23, v31, v223 row_newbcast:14 row_mask:0xf bank_mask:0xf
    v_dot2c_f32_bf16_dpp v16, v30, v224 row_newbcast:1 row_mask:0xf bank_mask:0xf
    v_dot2c_f32_bf16_dpp v17, v31, v224 row_newbcast:1 row_mask:0xf bank_mask:0xf
    v_dot2c_f32_bf16_dpp v18, v30, v225 row_newbcast:1 row_mask:0xf bank_mask:0xf
    v_dot2c_f32_bf16_dpp v19, v31, v225 row_newbcast:1 row_mask:0xf bank_mask:0xf
    v_dot2c_f32_bf16_dpp v20, v30, v226 row_newbcast:1 row_mask:0xf bank_mask:0xf
    v_dot2c_f32_bf16_dpp v21, v31, v226 row_newbcast:1 row_mask:0xf bank_mask:0xf
    v_dot2c_f32_bf16_dpp v22, v30, v227 row_newbcast:1 row_mask:0xf bank_mask:0xf
    v_dot2c_f32_bf16_dpp v23, v31, v227 row_newbcast:1 row_mask:0xf bank_mask:0xf
    v_dot2c_f32_bf16_dpp v16, v30, v228 row_newbcast:9 row_mask:0xf bank_mask:0xf
    v_dot2c_f32_bf16_dpp v17, v31, v228 row_newbcast:9 row_mask:0xf bank_mask:0xf
    v_dot2c_f32_bf16_dpp v18, v30, v229 row_newbcast:9 row_mask:0xf bank_mask:0xf
    v_dot2c_f32_bf16_dpp v19, v31, v229 row_newbcast:9 row_mask:0xf bank_mask:0xf
    v_dot2c_f32_bf16_dpp v20, v30, v230 row_newbcast:9 row_mask:0xf bank_mask:0xf
    v_dot2c_f32_bf16_dpp v21, v31, v230 row_newbcast:9 row_mask:0xf bank_mask:0xf
    v_dot2c_f32_bf16_dpp v22, v30, v231 row_newbcast:9 row_mask:0xf bank_mask:0xf
    v_dot2c_f32_bf16_dpp v23, v31, v231 row_newbcast:9 row_mask:0xf bank_mask:0xf
    v_dot2c_f32_bf16_dpp v16, v30, v232 row_newbcast:5 row_mask:0xf bank_mask:0xf
    v_dot2c_f32_bf16_dpp v17, v31, v232 row_newbcast:5 row_mask:0xf bank_mask:0xf
    v_dot2c_f32_bf16_dpp v18, v30, v233 row_newbcast:5 row_mask:0xf bank_mask:0xf
    v_dot2c_f32_bf16_dpp v19, v31, v233 row_newbcast:5 row_mask:0xf bank_mask:0xf
    v_dot2c_f32_bf16_dpp v20, v30, v234 row_newbcast:5 row_mask:0xf bank_mask:0xf
    v_dot2c_f32_bf16_dpp v21, v31, v234 row_newbcast:5 row_mask:0xf bank_mask:0xf
    v_dot2c_f32_bf16_dpp v22, v30, v235 row_newbcast:5 row_mask:0xf bank_mask:0xf
    v_dot2c_f32_bf16_dpp v23, v31, v235 row_newbcast:5 row_mask:0xf bank_mask:0xf
    v_dot2c_f32_bf16_dpp v16, v30, v236 row_newbcast:13 row_mask:0xf bank_mask:0xf
    v_dot2c_f32_bf16_dpp v17, v31, v236 row_newbcast:13 row_mask:0xf bank_mask:0xf
    v_dot2c_f32_bf16_dpp v18, v30, v237 row_newbcast:13 row_mask:0xf bank_mask:0xf
    v_dot2c_f32_bf16_dpp v19, v31, v237 row_newbcast:13 row_mask:0xf bank_mask:0xf
    v_dot2c_f32_bf16_dpp v20, v30, v238 row_newbcast:13 row_mask:0xf bank_mask:0xf
    v_dot2c_f32_bf16_dpp v21, v31, v238 row_newbcast:13 row_mask:0xf bank_mask:0xf
    v_dot2c_f32_bf16_dpp v22, v30, v239 row_newbcast:13 row_mask:0xf bank_mask:0xf
    v_dot2c_f32_bf16_dpp v23, v31, v239 row_newbcast:13 row_mask:0xf bank_mask:0xf
    s_waitcnt vmcnt(6)
    buffer_load_dwordx4 v[108:111], v8, s[56:59], s73 offen offset:2048 nt
    s_add_u32 s73, s73, 4096
    v_dot2c_f32_bf16_dpp v16, v30, v240 row_newbcast:3 row_mask:0xf bank_mask:0xf
    v_dot2c_f32_bf16_dpp v17, v31, v240 row_newbcast:3 row_mask:0xf bank_mask:0xf
    v_dot2c_f32_bf16_dpp v18, v30, v241 row_newbcast:3 row_mask:0xf bank_mask:0xf
    v_dot2c_f32_bf16_dpp v19, v31, v241 row_newbcast:3 row_mask:0xf bank_mask:0xf
    v_dot2c_f32_bf16_dpp v20, v30, v242 row_newbcast:3 row_mask:0xf bank_mask:0xf
    v_dot2c_f32_bf16_dpp v21, v31, v242 row_newbcast:3 row_mask:0xf bank_mask:0xf
    v_dot2c_f32_bf16_dpp v22, v30, v243 row_newbcast:3 row_mask:0xf bank_mask:0xf
    v_dot2c_f32_bf16_dpp v23, v31, v243 row_newbcast:3 row_mask:0xf bank_mask:0xf
    s_waitcnt vmcnt(6)
    buffer_load_dwordx4 v[112:115], v8, s[56:59], s73 offen offset:0 nt
    v_dot2c_f32_bf16_dpp v16, v30, v244 row_newbcast:11 row_mask:0xf bank_mask:0xf
    v_dot2c_f32_bf16_dpp v17, v31, v244 row_newbcast:11 row_mask:0xf bank_mask:0xf
    v_dot2c_f32_bf16_dpp v18, v30, v245 row_newbcast:11 row_mask:0xf bank_mask:0xf
    v_dot2c_f32_bf16_dpp v19, v31, v245 row_newbcast:11 row_mask:0xf bank_mask:0xf
    v_dot2c_f32_bf16_dpp v20, v30, v246 row_newbcast:11 row_mask:0xf bank_mask:0xf
    v_dot2c_f32_bf16_dpp v21, v31, v246 row_newbcast:11 row_mask:0xf bank_mask:0xf
    v_dot2c_f32_bf16_dpp v22, v30, v247 row_newbcast:11 row_mask:0xf bank_mask:0xf
    v_dot2c_f32_bf16_dpp v23, v31, v247 row_newbcast:11 row_mask:0xf bank_mask:0xf
    s_waitcnt vmcnt(6)
    buffer_load_dwordx4 v[116:119], v8, s[56:59], s73 offen offset:2048 nt
    s_add_u32 s73, s73, 4096
    v_dot2c_f32_bf16_dpp v16, v30, v248 row_newbcast:7 row_mask:0xf bank_mask:0xf
    v_dot2c_f32_bf16_dpp v17, v31, v248 row_newbcast:7 row_mask:0xf bank_mask:0xf
    v_dot2c_f32_bf16_dpp v18, v30, v249 row_newbcast:7 row_mask:0xf bank_mask:0xf
    v_dot2c_f32_bf16_dpp v19, v31, v249 row_newbcast:7 row_mask:0xf bank_mask:0xf
    v_dot2c_f32_bf16_dpp v20, v30, v250 row_newbcast:7 row_mask:0xf bank_mask:0xf
    v_dot2c_f32_bf16_dpp v21, v31, v250 row_newbcast:7 row_mask:0xf bank_mask:0xf
    v_dot2c_f32_bf16_dpp v22, v30, v251 row_newbcast:7 row_mask:0xf bank_mask:0xf
    v_dot2c_f32_bf16_dpp v23, v31, v251 row_newbcast:7 row_mask:0xf bank_mask:0xf
    s_waitcnt vmcnt(6)
    buffer_load_dwordx4 v[120:123], v8, s[56:59], s73 offen offset:0 nt
    v_dot2c_f32_bf16_dpp v16, v30, v252 row_newbcast:15 row_mask:0xf bank_mask:0xf
    v_dot2c_f32_bf16_dpp v17, v31, v252 row_newbcast:15 row_mask:0xf bank_mask:0xf
    v_dot2c_f32_bf16_dpp v18, v30, v253 row_newbcast:15 row_mask:0xf bank_mask:0xf
    v_dot2c_f32_bf16_dpp v19, v31, v253 row_newbcast:15 row_mask:0xf bank_mask:0xf
    v_dot2c_f32_bf16_dpp v20, v30, v254 row_newbcast:15 row_mask:0xf bank_mask:0xf
    v_dot2c_f32_bf16_dpp v21, v31, v254 row_newbcast:15 row_mask:0xf bank_mask:0xf
    v_dot2c_f32_bf16_dpp v22, v30, v255 row_newbcast:15 row_mask:0xf bank_mask:0xf
    v_dot2c_f32_bf16_dpp v23, v31, v255 row_newbcast:15 row_mask:0xf bank_mask:0xf
    buffer_load_dwordx4 v[124:127], v8, s[56:59], s73 offen offset:2048 nt
    s_mov_b64 exec, s[22:23]
    buffer_load_dwordx4 v[48:51], v61, s[60:63], s18 offen sc1
    s_mov_b64 exec, -1
    s_mov_b32 s73, 0
    buffer_load_dwordx4 v[64:67], v8, s[52:55], s73 offen offset:0 nt
    buffer_load_dwordx4 v[68:71], v8, s[52:55], s73 offen offset:2048 nt
    s_add_u32 s73, s73, 4096
    buffer_load_dwordx4 v[72:75], v8, s[52:55], s73 offen offset:0 nt
    buffer_load_dwordx4 v[76:79], v8, s[52:55], s73 offen offset:2048 nt
    s_add_u32 s73, s73, 4096
    v_permlane32_swap_b32 v16, v20
    v_permlane32_swap_b32 v17, v21
    v_permlane32_swap_b32 v18, v22
    v_permlane32_swap_b32 v19, v23
    v_add_f32 v16, v16, v20
    v_add_f32 v17, v17, v21
    v_add_f32 v18, v18, v22
    v_add_f32 v19, v19, v23
    s_nop 0
    v_permlane16_swap_b32 v16, v18
    v_permlane16_swap_b32 v17, v19
    v_add_f32 v16, v16, v18
    v_add_f32 v17, v17, v19
    v_lshrrev_b32 v12, 1, v11
    ds_write_b64 v12, v[16:17] offset:7168
    s_waitcnt lgkmcnt(0)
    s_barrier
    ds_read_b128 v[52:55], v1 offset:4640
    ds_read_b128 v[192:195], v60 offset:7168
    ds_read_b128 v[196:199], v60 offset:7680
    ds_read_b128 v[200:203], v60 offset:8192
    ds_read_b128 v[204:207], v60 offset:8704
    v_lshlrev_b32 v12, 1, v7
    ds_read_b128 v[24:27], v12 offset:4352
    ds_read_b32 v47, v1 offset:4672
    s_waitcnt lgkmcnt(2)
    v_mul_f32 v56, v52, v192
    v_mul_f32 v57, v52, v193
    v_mul_f32 v58, v52, v194
    v_mul_f32 v59, v52, v195
    v_fmac_f32 v56, v53, v196
    v_fmac_f32 v57, v53, v197
    v_fmac_f32 v58, v53, v198
    v_fmac_f32 v59, v53, v199
    v_fmac_f32 v56, v54, v200
    v_fmac_f32 v57, v54, v201
    v_fmac_f32 v58, v54, v202
    v_fmac_f32 v59, v54, v203
    v_fmac_f32 v56, v55, v204
    v_fmac_f32 v57, v55, v205
    v_fmac_f32 v58, v55, v206
    v_fmac_f32 v59, v55, v207
    v_and_or_b32 v56, v56, v15, s6
    v_and_or_b32 v57, v57, v15, s6
    v_and_or_b32 v58, v58, v15, s6
    v_and_or_b32 v59, v59, v15, s6
    s_mov_b64 exec, s[20:21]
    buffer_store_dwordx4 v[56:59], v60, s[60:63], s19 offen sc1
    s_mov_b64 exec, -1
    s_waitcnt vmcnt(7)
    buffer_load_dwordx4 v[80:83], v8, s[52:55], s73 offen offset:0 nt
    s_waitcnt vmcnt(7)
    buffer_load_dwordx4 v[84:87], v8, s[52:55], s73 offen offset:2048 nt
    s_add_u32 s73, s73, 4096
    s_waitcnt vmcnt(7)
    buffer_load_dwordx4 v[88:91], v8, s[52:55], s73 offen offset:0 nt
    s_waitcnt vmcnt(7)
    buffer_load_dwordx4 v[92:95], v8, s[52:55], s73 offen offset:2048 nt
    v_mov_b32 v16, 0
    v_mov_b32 v192, 0
    v_mov_b32 v17, 0
    v_mov_b32 v193, 0
    v_mov_b32 v18, 0
    v_mov_b32 v194, 0
    v_mov_b32 v19, 0
    v_mov_b32 v195, 0
    v_mov_b32 v20, 0
    v_mov_b32 v196, 0
    v_mov_b32 v21, 0
    v_mov_b32 v197, 0
    v_mov_b32 v22, 0
    v_mov_b32 v198, 0
    v_mov_b32 v23, 0
    v_mov_b32 v199, 0
    v_perm_b32 v160, v100, v96, s74
    v_perm_b32 v161, v100, v96, s75
    v_perm_b32 v162, v101, v97, s74
    v_perm_b32 v163, v101, v97, s75
    v_perm_b32 v164, v102, v98, s74
    v_perm_b32 v165, v102, v98, s75
    v_perm_b32 v166, v103, v99, s74
    v_perm_b32 v167, v103, v99, s75
    v_perm_b32 v168, v108, v104, s74
    v_perm_b32 v169, v108, v104, s75
    v_perm_b32 v170, v109, v105, s74
    v_perm_b32 v171, v109, v105, s75
    v_perm_b32 v172, v110, v106, s74
    v_perm_b32 v173, v110, v106, s75
    v_perm_b32 v174, v111, v107, s74
    v_perm_b32 v175, v111, v107, s75
    v_perm_b32 v176, v116, v112, s74
    v_perm_b32 v177, v116, v112, s75
    v_perm_b32 v178, v117, v113, s74
    v_perm_b32 v179, v117, v113, s75
    v_perm_b32 v180, v118, v114, s74
    v_perm_b32 v181, v118, v114, s75
    v_perm_b32 v182, v119, v115, s74
    v_perm_b32 v183, v119, v115, s75
    v_perm_b32 v184, v124, v120, s74
    v_perm_b32 v185, v124, v120, s75
    v_perm_b32 v186, v125, v121, s74
    v_perm_b32 v187, v125, v121, s75
    v_perm_b32 v188, v126, v122, s74
    v_perm_b32 v189, v126, v122, s75
    v_perm_b32 v190, v127, v123, s74
    v_perm_b32 v191, v127, v123, s75
    s_waitcnt lgkmcnt(0)
    v_readfirstlane_b32 s72, v47
    v_cndmask_b32 v48, v48, v56, s[20:21]
    v_cndmask_b32 v49, v49, v57, s[20:21]
    v_cndmask_b32 v50, v50, v58, s[20:21]
    v_cndmask_b32 v51, v51, v59, s[20:21]
    v_bitop3_b32 v42, v48, v49, s6 bitop3:0x7e
    v_bitop3_b32 v43, v50, v51, s6 bitop3:0x7e
    v_or_b32 v42, v42, v43
    v_and_b32 v42, 0xff, v42
    v_cmp_ne_u32 vcc, 0, v42
    s_nop 0
    s_cmp_eq_u64 vcc, 0
    s_cbranch_scc1 L_ready
    s_mov_b64 s[16:17], vcc
    s_waitcnt vmcnt(7)
    v_perm_b32 v128, v68, v64, s74
    v_perm_b32 v129, v68, v64, s75
    v_perm_b32 v130, v69, v65, s74
    v_perm_b32 v131, v69, v65, s75
    v_perm_b32 v132, v70, v66, s74
    v_perm_b32 v133, v70, v66, s75
    v_perm_b32 v134, v71, v67, s74
    v_perm_b32 v135, v71, v67, s75
    v_dot2c_f32_bf16 v16, v24, v128
    v_dot2c_f32_bf16 v17, v24, v129
    v_dot2c_f32_bf16 v18, v24, v130
    v_dot2c_f32_bf16 v19, v24, v131
    v_dot2c_f32_bf16 v20, v24, v132
    v_dot2c_f32_bf16 v21, v24, v133
    v_dot2c_f32_bf16 v22, v24, v134
    v_dot2c_f32_bf16 v23, v24, v135
    s_waitcnt vmcnt(5)
    v_perm_b32 v136, v76, v72, s74
    v_perm_b32 v137, v76, v72, s75
    v_perm_b32 v138, v77, v73, s74
    v_perm_b32 v139, v77, v73, s75
    v_perm_b32 v140, v78, v74, s74
    v_perm_b32 v141, v78, v74, s75
    v_perm_b32 v142, v79, v75, s74
    v_perm_b32 v143, v79, v75, s75
    v_dot2c_f32_bf16 v16, v25, v136
    v_dot2c_f32_bf16 v17, v25, v137
    v_dot2c_f32_bf16 v18, v25, v138
    v_dot2c_f32_bf16 v19, v25, v139
    v_dot2c_f32_bf16 v20, v25, v140
    v_dot2c_f32_bf16 v21, v25, v141
    v_dot2c_f32_bf16 v22, v25, v142
    v_dot2c_f32_bf16 v23, v25, v143
    s_waitcnt vmcnt(2)
    v_perm_b32 v144, v84, v80, s74
    v_perm_b32 v145, v84, v80, s75
    v_perm_b32 v146, v85, v81, s74
    v_perm_b32 v147, v85, v81, s75
    v_perm_b32 v148, v86, v82, s74
    v_perm_b32 v149, v86, v82, s75
    v_perm_b32 v150, v87, v83, s74
    v_perm_b32 v151, v87, v83, s75
    v_dot2c_f32_bf16 v16, v26, v144
    v_dot2c_f32_bf16 v17, v26, v145
    v_dot2c_f32_bf16 v18, v26, v146
    v_dot2c_f32_bf16 v19, v26, v147
    v_dot2c_f32_bf16 v20, v26, v148
    v_dot2c_f32_bf16 v21, v26, v149
    v_dot2c_f32_bf16 v22, v26, v150
    v_dot2c_f32_bf16 v23, v26, v151
    s_waitcnt vmcnt(0)
    v_perm_b32 v152, v92, v88, s74
    v_perm_b32 v153, v92, v88, s75
    v_perm_b32 v154, v93, v89, s74
    v_perm_b32 v155, v93, v89, s75
    v_perm_b32 v156, v94, v90, s74
    v_perm_b32 v157, v94, v90, s75
    v_perm_b32 v158, v95, v91, s74
    v_perm_b32 v159, v95, v91, s75
    v_dot2c_f32_bf16 v16, v27, v152
    v_dot2c_f32_bf16 v17, v27, v153
    v_dot2c_f32_bf16 v18, v27, v154
    v_dot2c_f32_bf16 v19, v27, v155
    v_dot2c_f32_bf16 v20, v27, v156
    v_dot2c_f32_bf16 v21, v27, v157
    v_dot2c_f32_bf16 v22, v27, v158
    v_dot2c_f32_bf16 v23, v27, v159
    v_permlane32_swap_b32 v16, v20
    v_permlane32_swap_b32 v17, v21
    v_permlane32_swap_b32 v18, v22
    v_permlane32_swap_b32 v19, v23
    v_add_f32 v16, v16, v20
    v_add_f32 v17, v17, v21
    v_add_f32 v18, v18, v22
    v_add_f32 v19, v19, v23
    s_nop 0
    v_permlane16_swap_b32 v16, v18
    v_permlane16_swap_b32 v17, v19
    v_add_f32 v16, v16, v18
    v_add_f32 v17, v17, v19
    s_mov_b64 vcc, s[16:17]
    s_or_b32 s7, vcc_lo, vcc_hi
    s_lshr_b32 s8, s7, 16
    s_or_b32 s7, s7, s8
    s_lshr_b32 s8, s7, 8
    s_or_b32 s7, s7, s8
    s_and_b32 s7, s7, 0xff
    s_mul_i32 s7, s7, 0x01010101
    s_mov_b32 exec_lo, s7
    s_mov_b32 exec_hi, s7
    s_mov_b32 s76, 2000000
L_poll97:
    buffer_load_dwordx4 v[48:51], v61, s[60:63], s18 offen sc1
    s_waitcnt vmcnt(0)
    v_bitop3_b32 v42, v48, v49, s6 bitop3:0x7e
    v_bitop3_b32 v43, v50, v51, s6 bitop3:0x7e
    v_or_b32 v42, v42, v43
    v_and_b32 v42, 0xff, v42
    v_cmp_ne_u32 vcc, 0, v42
    s_nop 0
    s_cmp_eq_u64 vcc, 0
    s_cbranch_scc1 L_polld97
    s_sub_u32 s76, s76, 1
    s_cbranch_scc1 L_polld97
    s_or_b32 s7, vcc_lo, vcc_hi
    s_lshr_b32 s8, s7, 16
    s_or_b32 s7, s7, s8
    s_lshr_b32 s8, s7, 8
    s_or_b32 s7, s7, s8
    s_and_b32 s7, s7, 0xff
    s_mul_i32 s7, s7, 0x01010101
    s_mov_b32 exec_lo, s7
    s_mov_b32 exec_hi, s7
    s_branch L_poll97
L_polld97:
    s_mov_b64 exec, -1
    v_and_b32 v48, v48, v15
    v_and_b32 v49, v49, v15
    v_and_b32 v50, v50, v15
    v_and_b32 v51, v51, v15
    v_add_f32_dpp v48, v48, v48 quad_perm:[1,0,3,2] row_mask:0xf bank_mask:0xf
    v_add_f32_dpp v49, v49, v49 quad_perm:[1,0,3,2] row_mask:0xf bank_mask:0xf
    v_add_f32_dpp v50, v50, v50 quad_perm:[1,0,3,2] row_mask:0xf bank_mask:0xf
    v_add_f32_dpp v51, v51, v51 quad_perm:[1,0,3,2] row_mask:0xf bank_mask:0xf
    v_add_f32_dpp v48, v48, v48 quad_perm:[2,3,0,1] row_mask:0xf bank_mask:0xf
    v_add_f32_dpp v49, v49, v49 quad_perm:[2,3,0,1] row_mask:0xf bank_mask:0xf
    v_add_f32_dpp v50, v50, v50 quad_perm:[2,3,0,1] row_mask:0xf bank_mask:0xf
    v_add_f32_dpp v51, v51, v51 quad_perm:[2,3,0,1] row_mask:0xf bank_mask:0xf
    v_add_f32_dpp v48, v48, v48 row_half_mirror row_mask:0xf bank_mask:0xf
    v_add_f32_dpp v49, v49, v49 row_half_mirror row_mask:0xf bank_mask:0xf
    v_add_f32_dpp v50, v50, v50 row_half_mirror row_mask:0xf bank_mask:0xf
    v_add_f32_dpp v51, v51, v51 row_half_mirror row_mask:0xf bank_mask:0xf
    v_cvt_pk_bf16_f32 v30, v48, v49
    v_cvt_pk_bf16_f32 v31, v50, v51
    s_nop 0
    v_dot2c_f32_bf16_dpp v192, v30, v160 row_newbcast:0 row_mask:0xf bank_mask:0xf
    v_dot2c_f32_bf16_dpp v193, v30, v161 row_newbcast:0 row_mask:0xf bank_mask:0xf
    v_dot2c_f32_bf16_dpp v194, v30, v162 row_newbcast:0 row_mask:0xf bank_mask:0xf
    v_dot2c_f32_bf16_dpp v195, v30, v163 row_newbcast:0 row_mask:0xf bank_mask:0xf
    v_dot2c_f32_bf16_dpp v196, v30, v164 row_newbcast:0 row_mask:0xf bank_mask:0xf
    v_dot2c_f32_bf16_dpp v197, v30, v165 row_newbcast:0 row_mask:0xf bank_mask:0xf
    v_dot2c_f32_bf16_dpp v198, v30, v166 row_newbcast:0 row_mask:0xf bank_mask:0xf
    v_dot2c_f32_bf16_dpp v199, v30, v167 row_newbcast:0 row_mask:0xf bank_mask:0xf
    v_dot2c_f32_bf16_dpp v192, v31, v168 row_newbcast:0 row_mask:0xf bank_mask:0xf
    v_dot2c_f32_bf16_dpp v193, v31, v169 row_newbcast:0 row_mask:0xf bank_mask:0xf
    v_dot2c_f32_bf16_dpp v194, v31, v170 row_newbcast:0 row_mask:0xf bank_mask:0xf
    v_dot2c_f32_bf16_dpp v195, v31, v171 row_newbcast:0 row_mask:0xf bank_mask:0xf
    v_dot2c_f32_bf16_dpp v196, v31, v172 row_newbcast:0 row_mask:0xf bank_mask:0xf
    v_dot2c_f32_bf16_dpp v197, v31, v173 row_newbcast:0 row_mask:0xf bank_mask:0xf
    v_dot2c_f32_bf16_dpp v198, v31, v174 row_newbcast:0 row_mask:0xf bank_mask:0xf
    v_dot2c_f32_bf16_dpp v199, v31, v175 row_newbcast:0 row_mask:0xf bank_mask:0xf
    v_dot2c_f32_bf16_dpp v192, v30, v176 row_newbcast:8 row_mask:0xf bank_mask:0xf
    v_dot2c_f32_bf16_dpp v193, v30, v177 row_newbcast:8 row_mask:0xf bank_mask:0xf
    v_dot2c_f32_bf16_dpp v194, v30, v178 row_newbcast:8 row_mask:0xf bank_mask:0xf
    v_dot2c_f32_bf16_dpp v195, v30, v179 row_newbcast:8 row_mask:0xf bank_mask:0xf
    v_dot2c_f32_bf16_dpp v196, v30, v180 row_newbcast:8 row_mask:0xf bank_mask:0xf
    v_dot2c_f32_bf16_dpp v197, v30, v181 row_newbcast:8 row_mask:0xf bank_mask:0xf
    v_dot2c_f32_bf16_dpp v198, v30, v182 row_newbcast:8 row_mask:0xf bank_mask:0xf
    v_dot2c_f32_bf16_dpp v199, v30, v183 row_newbcast:8 row_mask:0xf bank_mask:0xf
    v_dot2c_f32_bf16_dpp v192, v31, v184 row_newbcast:8 row_mask:0xf bank_mask:0xf
    v_dot2c_f32_bf16_dpp v193, v31, v185 row_newbcast:8 row_mask:0xf bank_mask:0xf
    v_dot2c_f32_bf16_dpp v194, v31, v186 row_newbcast:8 row_mask:0xf bank_mask:0xf
    v_dot2c_f32_bf16_dpp v195, v31, v187 row_newbcast:8 row_mask:0xf bank_mask:0xf
    v_dot2c_f32_bf16_dpp v196, v31, v188 row_newbcast:8 row_mask:0xf bank_mask:0xf
    v_dot2c_f32_bf16_dpp v197, v31, v189 row_newbcast:8 row_mask:0xf bank_mask:0xf
    v_dot2c_f32_bf16_dpp v198, v31, v190 row_newbcast:8 row_mask:0xf bank_mask:0xf
    v_dot2c_f32_bf16_dpp v199, v31, v191 row_newbcast:8 row_mask:0xf bank_mask:0xf
    v_permlane32_swap_b32 v192, v196
    v_permlane32_swap_b32 v193, v197
    v_permlane32_swap_b32 v194, v198
    v_permlane32_swap_b32 v195, v199
    v_add_f32 v192, v192, v196
    v_add_f32 v193, v193, v197
    v_add_f32 v194, v194, v198
    v_add_f32 v195, v195, v199
    s_nop 0
    v_permlane16_swap_b32 v192, v194
    v_permlane16_swap_b32 v193, v195
    v_add_f32 v192, v192, v194
    v_add_f32 v193, v193, v195
    s_branch L_both
L_ready:
    v_and_b32 v48, v48, v15
    v_and_b32 v49, v49, v15
    v_and_b32 v50, v50, v15
    v_and_b32 v51, v51, v15
    v_add_f32_dpp v48, v48, v48 quad_perm:[1,0,3,2] row_mask:0xf bank_mask:0xf
    v_add_f32_dpp v49, v49, v49 quad_perm:[1,0,3,2] row_mask:0xf bank_mask:0xf
    v_add_f32_dpp v50, v50, v50 quad_perm:[1,0,3,2] row_mask:0xf bank_mask:0xf
    v_add_f32_dpp v51, v51, v51 quad_perm:[1,0,3,2] row_mask:0xf bank_mask:0xf
    v_add_f32_dpp v48, v48, v48 quad_perm:[2,3,0,1] row_mask:0xf bank_mask:0xf
    v_add_f32_dpp v49, v49, v49 quad_perm:[2,3,0,1] row_mask:0xf bank_mask:0xf
    v_add_f32_dpp v50, v50, v50 quad_perm:[2,3,0,1] row_mask:0xf bank_mask:0xf
    v_add_f32_dpp v51, v51, v51 quad_perm:[2,3,0,1] row_mask:0xf bank_mask:0xf
    v_add_f32_dpp v48, v48, v48 row_half_mirror row_mask:0xf bank_mask:0xf
    v_add_f32_dpp v49, v49, v49 row_half_mirror row_mask:0xf bank_mask:0xf
    v_add_f32_dpp v50, v50, v50 row_half_mirror row_mask:0xf bank_mask:0xf
    v_add_f32_dpp v51, v51, v51 row_half_mirror row_mask:0xf bank_mask:0xf
    v_cvt_pk_bf16_f32 v30, v48, v49
    v_cvt_pk_bf16_f32 v31, v50, v51
    s_nop 0
    v_dot2c_f32_bf16_dpp v192, v30, v160 row_newbcast:0 row_mask:0xf bank_mask:0xf
    v_dot2c_f32_bf16_dpp v193, v30, v161 row_newbcast:0 row_mask:0xf bank_mask:0xf
    v_dot2c_f32_bf16_dpp v194, v30, v162 row_newbcast:0 row_mask:0xf bank_mask:0xf
    v_dot2c_f32_bf16_dpp v195, v30, v163 row_newbcast:0 row_mask:0xf bank_mask:0xf
    v_dot2c_f32_bf16_dpp v196, v30, v164 row_newbcast:0 row_mask:0xf bank_mask:0xf
    v_dot2c_f32_bf16_dpp v197, v30, v165 row_newbcast:0 row_mask:0xf bank_mask:0xf
    v_dot2c_f32_bf16_dpp v198, v30, v166 row_newbcast:0 row_mask:0xf bank_mask:0xf
    v_dot2c_f32_bf16_dpp v199, v30, v167 row_newbcast:0 row_mask:0xf bank_mask:0xf
    v_dot2c_f32_bf16_dpp v192, v31, v168 row_newbcast:0 row_mask:0xf bank_mask:0xf
    v_dot2c_f32_bf16_dpp v193, v31, v169 row_newbcast:0 row_mask:0xf bank_mask:0xf
    v_dot2c_f32_bf16_dpp v194, v31, v170 row_newbcast:0 row_mask:0xf bank_mask:0xf
    v_dot2c_f32_bf16_dpp v195, v31, v171 row_newbcast:0 row_mask:0xf bank_mask:0xf
    v_dot2c_f32_bf16_dpp v196, v31, v172 row_newbcast:0 row_mask:0xf bank_mask:0xf
    v_dot2c_f32_bf16_dpp v197, v31, v173 row_newbcast:0 row_mask:0xf bank_mask:0xf
    v_dot2c_f32_bf16_dpp v198, v31, v174 row_newbcast:0 row_mask:0xf bank_mask:0xf
    v_dot2c_f32_bf16_dpp v199, v31, v175 row_newbcast:0 row_mask:0xf bank_mask:0xf
    v_dot2c_f32_bf16_dpp v192, v30, v176 row_newbcast:8 row_mask:0xf bank_mask:0xf
    v_dot2c_f32_bf16_dpp v193, v30, v177 row_newbcast:8 row_mask:0xf bank_mask:0xf
    v_dot2c_f32_bf16_dpp v194, v30, v178 row_newbcast:8 row_mask:0xf bank_mask:0xf
    v_dot2c_f32_bf16_dpp v195, v30, v179 row_newbcast:8 row_mask:0xf bank_mask:0xf
    v_dot2c_f32_bf16_dpp v196, v30, v180 row_newbcast:8 row_mask:0xf bank_mask:0xf
    v_dot2c_f32_bf16_dpp v197, v30, v181 row_newbcast:8 row_mask:0xf bank_mask:0xf
    v_dot2c_f32_bf16_dpp v198, v30, v182 row_newbcast:8 row_mask:0xf bank_mask:0xf
    v_dot2c_f32_bf16_dpp v199, v30, v183 row_newbcast:8 row_mask:0xf bank_mask:0xf
    v_dot2c_f32_bf16_dpp v192, v31, v184 row_newbcast:8 row_mask:0xf bank_mask:0xf
    v_dot2c_f32_bf16_dpp v193, v31, v185 row_newbcast:8 row_mask:0xf bank_mask:0xf
    v_dot2c_f32_bf16_dpp v194, v31, v186 row_newbcast:8 row_mask:0xf bank_mask:0xf
    v_dot2c_f32_bf16_dpp v195, v31, v187 row_newbcast:8 row_mask:0xf bank_mask:0xf
    v_dot2c_f32_bf16_dpp v196, v31, v188 row_newbcast:8 row_mask:0xf bank_mask:0xf
    v_dot2c_f32_bf16_dpp v197, v31, v189 row_newbcast:8 row_mask:0xf bank_mask:0xf
    v_dot2c_f32_bf16_dpp v198, v31, v190 row_newbcast:8 row_mask:0xf bank_mask:0xf
    v_dot2c_f32_bf16_dpp v199, v31, v191 row_newbcast:8 row_mask:0xf bank_mask:0xf
    v_permlane32_swap_b32 v192, v196
    v_permlane32_swap_b32 v193, v197
    v_permlane32_swap_b32 v194, v198
    v_permlane32_swap_b32 v195, v199
    v_add_f32 v192, v192, v196
    v_add_f32 v193, v193, v197
    v_add_f32 v194, v194, v198
    v_add_f32 v195, v195, v199
    s_nop 0
    v_permlane16_swap_b32 v192, v194
    v_permlane16_swap_b32 v193, v195
    v_add_f32 v192, v192, v194
    v_add_f32 v193, v193, v195
    s_waitcnt vmcnt(7)
    v_perm_b32 v128, v68, v64, s74
    v_perm_b32 v129, v68, v64, s75
    v_perm_b32 v130, v69, v65, s74
    v_perm_b32 v131, v69, v65, s75
    v_perm_b32 v132, v70, v66, s74
    v_perm_b32 v133, v70, v66, s75
    v_perm_b32 v134, v71, v67, s74
    v_perm_b32 v135, v71, v67, s75
    v_dot2c_f32_bf16 v16, v24, v128
    v_dot2c_f32_bf16 v17, v24, v129
    v_dot2c_f32_bf16 v18, v24, v130
    v_dot2c_f32_bf16 v19, v24, v131
    v_dot2c_f32_bf16 v20, v24, v132
    v_dot2c_f32_bf16 v21, v24, v133
    v_dot2c_f32_bf16 v22, v24, v134
    v_dot2c_f32_bf16 v23, v24, v135
    s_waitcnt vmcnt(5)
    v_perm_b32 v136, v76, v72, s74
    v_perm_b32 v137, v76, v72, s75
    v_perm_b32 v138, v77, v73, s74
    v_perm_b32 v139, v77, v73, s75
    v_perm_b32 v140, v78, v74, s74
    v_perm_b32 v141, v78, v74, s75
    v_perm_b32 v142, v79, v75, s74
    v_perm_b32 v143, v79, v75, s75
    v_dot2c_f32_bf16 v16, v25, v136
    v_dot2c_f32_bf16 v17, v25, v137
    v_dot2c_f32_bf16 v18, v25, v138
    v_dot2c_f32_bf16 v19, v25, v139
    v_dot2c_f32_bf16 v20, v25, v140
    v_dot2c_f32_bf16 v21, v25, v141
    v_dot2c_f32_bf16 v22, v25, v142
    v_dot2c_f32_bf16 v23, v25, v143
    s_waitcnt vmcnt(2)
    v_perm_b32 v144, v84, v80, s74
    v_perm_b32 v145, v84, v80, s75
    v_perm_b32 v146, v85, v81, s74
    v_perm_b32 v147, v85, v81, s75
    v_perm_b32 v148, v86, v82, s74
    v_perm_b32 v149, v86, v82, s75
    v_perm_b32 v150, v87, v83, s74
    v_perm_b32 v151, v87, v83, s75
    v_dot2c_f32_bf16 v16, v26, v144
    v_dot2c_f32_bf16 v17, v26, v145
    v_dot2c_f32_bf16 v18, v26, v146
    v_dot2c_f32_bf16 v19, v26, v147
    v_dot2c_f32_bf16 v20, v26, v148
    v_dot2c_f32_bf16 v21, v26, v149
    v_dot2c_f32_bf16 v22, v26, v150
    v_dot2c_f32_bf16 v23, v26, v151
    s_waitcnt vmcnt(0)
    v_perm_b32 v152, v92, v88, s74
    v_perm_b32 v153, v92, v88, s75
    v_perm_b32 v154, v93, v89, s74
    v_perm_b32 v155, v93, v89, s75
    v_perm_b32 v156, v94, v90, s74
    v_perm_b32 v157, v94, v90, s75
    v_perm_b32 v158, v95, v91, s74
    v_perm_b32 v159, v95, v91, s75
    v_dot2c_f32_bf16 v16, v27, v152
    v_dot2c_f32_bf16 v17, v27, v153
    v_dot2c_f32_bf16 v18, v27, v154
    v_dot2c_f32_bf16 v19, v27, v155
    v_dot2c_f32_bf16 v20, v27, v156
    v_dot2c_f32_bf16 v21, v27, v157
    v_dot2c_f32_bf16 v22, v27, v158
    v_dot2c_f32_bf16 v23, v27, v159
    v_permlane32_swap_b32 v16, v20
    v_permlane32_swap_b32 v17, v21
    v_permlane32_swap_b32 v18, v22
    v_permlane32_swap_b32 v19, v23
    v_add_f32 v16, v16, v20
    v_add_f32 v17, v17, v21
    v_add_f32 v18, v18, v22
    v_add_f32 v19, v19, v23
    s_nop 0
    v_permlane16_swap_b32 v16, v18
    v_permlane16_swap_b32 v17, v19
    v_add_f32 v16, v16, v18
    v_add_f32 v17, v17, v19
L_both:
    v_mov_b32 v18, v192
    v_mov_b32 v19, v193
    ds_write_b128 v11, v[16:19] offset:9216
    s_waitcnt lgkmcnt(0)
    s_barrier
    s_cmp_lg_u32 s3, 0
    s_cbranch_scc1 L_end
    ds_read_b128 v[44:47], v4 offset:9216
    ds_read_b128 v[48:51], v4 offset:10240
    ds_read_b128 v[52:55], v4 offset:11264
    ds_read_b128 v[56:59], v4 offset:12288
    s_lshl_b32 s8, s2, 9
    s_add_u32 s8, s8, 786432
    s_add_u32 s9, s8, 131072
    v_lshrrev_b32 v12, 1, v4
    s_add_u32 s7, s9, 786432
    s_add_u32 s77, s8, 786432
    s_waitcnt lgkmcnt(0)
    v_add_f32 v46, v46, v50
    v_add_f32 v54, v54, v58
    v_add_f32 v47, v47, v51
    v_add_f32 v55, v55, v59
    v_add_f32 v44, v44, v48
    v_add_f32 v52, v52, v56
    v_add_f32 v45, v45, v49
    v_add_f32 v53, v53, v57
    v_add_f32 v46, v46, v54
    v_add_f32 v47, v47, v55
    v_add_f32 v44, v44, v52
    v_add_f32 v45, v45, v53
    v_and_or_b32 v46, v46, v15, s6
    v_and_or_b32 v47, v47, v15, s6
    v_and_or_b32 v44, v44, v15, s6
    v_and_or_b32 v45, v45, v15, s6
    buffer_store_dwordx2 v[46:47], v12, s[60:63], s7 offen
    buffer_store_dwordx2 v[44:45], v12, s[60:63], s77 offen
    buffer_store_dwordx2 v[46:47], v12, s[60:63], s9 offen sc1
    buffer_store_dwordx2 v[44:45], v12, s[60:63], s8 offen sc1
    s_cmp_ge_u32 s4, 8
    s_cbranch_scc1 L_fin
    v_lshrrev_b32 v13, 3, v0
    v_lshlrev_b32 v13, 12, v13
    v_lshl_add_u32 v13, v6, 4, v13
    s_lshr_b32 s7, s4, 2
    s_mul_i32 s9, s7, 131072
    s_lshl_b32 s8, s5, 9
    s_add_u32 s9, s9, s8
    s_and_b32 s77, s4, 3
    s_lshl_b32 s8, s77, 7
    s_add_u32 s9, s9, s8
    s_add_u32 s9, s9, 786432
    s_add_u32 s78, s9, 32768
    s_add_u32 s79, s9, 65536
    s_add_u32 s73, s9, 98304
    s_mov_b32 s68, s36
    s_mov_b32 s69, s37
    s_mov_b32 s70, 4096
    s_mov_b32 s71, 0x20000
    s_lshl_b32 s7, s7, 11
    s_lshl_b32 s8, s5, 8
    s_add_u32 s7, s7, s8
    s_lshl_b32 s8, s77, 6
    s_add_u32 s7, s7, s8
    v_lshl_add_u32 v14, v6, 3, s7
    v_lshrrev_b32 v12, 5, v0
    v_lshl_add_u32 v14, v12, 2, v14
    s_cmp_eq_u32 s72, 0
    s_cbranch_scc1 L_far
    v_add_u32 v13, 786432, v13
    s_mov_b32 s76, 50000
L_poll98:
    buffer_load_dwordx4 v[48:51], v13, s[60:63], s9 offen nt
    buffer_load_dwordx4 v[52:55], v13, s[60:63], s78 offen nt
    buffer_load_dwordx4 v[56:59], v13, s[60:63], s79 offen nt
    buffer_load_dwordx4 v[60:63], v13, s[60:63], s73 offen nt
    s_waitcnt vmcnt(0)
    v_bitop3_b32 v42, v48, v49, s6 bitop3:0x7e
    v_bitop3_b32 v43, v50, v51, s6 bitop3:0x7e
    v_bitop3_b32 v41, v52, v53, s6 bitop3:0x7e
    v_or3_b32 v42, v42, v43, v41
    v_bitop3_b32 v43, v54, v55, s6 bitop3:0x7e
    v_bitop3_b32 v41, v56, v57, s6 bitop3:0x7e
    v_or3_b32 v42, v42, v43, v41
    v_bitop3_b32 v43, v58, v59, s6 bitop3:0x7e
    v_bitop3_b32 v41, v60, v61, s6 bitop3:0x7e
    v_or3_b32 v42, v42, v43, v41
    v_bitop3_b32 v43, v62, v63, s6 bitop3:0x7e
    v_or_b32 v42, v42, v43
    v_and_b32 v42, 0xff, v42
    v_cmp_ne_u32 vcc, 0, v42
    s_nop 0
    s_cmp_eq_u64 vcc, 0
    s_cbranch_scc1 L_polld98
    s_sub_u32 s76, s76, 1
    s_cbranch_scc1 L_back
    s_branch L_poll98
L_polld98:
    s_branch L_got
L_back:
    v_subrev_u32 v13, 786432, v13
L_far:
    s_mov_b32 s76, 2000000
L_poll99:
    buffer_load_dwordx4 v[48:51], v13, s[60:63], s9 offen sc1
    buffer_load_dwordx4 v[52:55], v13, s[60:63], s78 offen sc1
    buffer_load_dwordx4 v[56:59], v13, s[60:63], s79 offen sc1
    buffer_load_dwordx4 v[60:63], v13, s[60:63], s73 offen sc1
    s_waitcnt vmcnt(0)
    v_bitop3_b32 v42, v48, v49, s6 bitop3:0x7e
    v_bitop3_b32 v43, v50, v51, s6 bitop3:0x7e
    v_bitop3_b32 v41, v52, v53, s6 bitop3:0x7e
    v_or3_b32 v42, v42, v43, v41
    v_bitop3_b32 v43, v54, v55, s6 bitop3:0x7e
    v_bitop3_b32 v41, v56, v57, s6 bitop3:0x7e
    v_or3_b32 v42, v42, v43, v41
    v_bitop3_b32 v43, v58, v59, s6 bitop3:0x7e
    v_bitop3_b32 v41, v60, v61, s6 bitop3:0x7e
    v_or3_b32 v42, v42, v43, v41
    v_bitop3_b32 v43, v62, v63, s6 bitop3:0x7e
    v_or_b32 v42, v42, v43
    v_and_b32 v42, 0xff, v42
    v_cmp_ne_u32 vcc, 0, v42
    s_nop 0
    s_cmp_eq_u64 vcc, 0
    s_cbranch_scc1 L_polld99
    s_sub_u32 s76, s76, 1
    s_cbranch_scc1 L_polld99
    s_lshr_b64 s[16:17], vcc, 4
    s_or_b64 vcc, vcc, s[16:17]
    s_lshr_b64 s[16:17], vcc, 2
    s_or_b64 vcc, vcc, s[16:17]
    s_lshr_b64 s[16:17], vcc, 1
    s_or_b64 vcc, vcc, s[16:17]
    s_and_b32 s7, vcc_lo, 0x01010101
    s_and_b32 s8, vcc_hi, 0x01010101
    s_mul_i32 exec_lo, s7, 0xff
    s_mul_i32 exec_hi, s8, 0xff
    s_branch L_poll99
L_polld99:
    s_mov_b64 exec, -1
L_got:
    v_and_b32 v48, v48, v15
    v_and_b32 v49, v49, v15
    v_and_b32 v50, v50, v15
    v_and_b32 v51, v51, v15
    v_and_b32 v52, v52, v15
    v_and_b32 v53, v53, v15
    v_and_b32 v54, v54, v15
    v_and_b32 v55, v55, v15
    v_and_b32 v56, v56, v15
    v_and_b32 v57, v57, v15
    v_and_b32 v58, v58, v15
    v_and_b32 v59, v59, v15
    v_and_b32 v60, v60, v15
    v_and_b32 v61, v61, v15
    v_and_b32 v62, v62, v15
    v_and_b32 v63, v63, v15
    v_add_f32 v48, v48, v52
    v_add_f32 v56, v56, v60
    v_add_f32 v49, v49, v53
    v_add_f32 v57, v57, v61
    v_add_f32 v50, v50, v54
    v_add_f32 v58, v58, v62
    v_add_f32 v51, v51, v55
    v_add_f32 v59, v59, v63
    v_add_f32 v48, v48, v56
    v_add_f32 v49, v49, v57
    v_add_f32 v50, v50, v58
    v_add_f32 v51, v51, v59
    s_nop 0
    v_permlane32_swap_b32 v48, v50
    v_permlane32_swap_b32 v49, v51
    v_add_f32 v48, v48, v50
    v_add_f32 v49, v49, v51
    s_nop 0
    v_add_f32_dpp v48, v48, v48 row_ror:8 row_mask:0xf bank_mask:0xf
    v_add_f32_dpp v49, v49, v49 row_ror:8 row_mask:0xf bank_mask:0xf
    v_mov_b32 v50, v48
    v_mov_b32 v51, v49
    s_nop 0
    v_permlane16_swap_b32 v48, v50
    v_permlane16_swap_b32 v49, v51
    v_add_f32 v48, v48, v50
    v_add_f32 v49, v49, v51
    v_cvt_pk_bf16_f32 v52, v48, v49
    s_mov_b32 exec_lo, 0xff
    s_mov_b32 exec_hi, 0xff
    buffer_store_dword v52, v14, s[68:71], 0 offen
    s_cmp_lg_u32 s2, 0
    s_cbranch_scc1 L_fin
    s_mov_b64 exec, 1
    v_mov_b32 v46, s6
    buffer_store_dword v46, v1, s[60:63], 0 offen sc1
L_fin:
    s_endpgm
L_side:
    s_mov_b32 s10, 0xcccccccc
    s_mov_b32 s11, 0xcccccccc
    s_mov_b32 s12, 0xaaaaaaaa
    s_mov_b32 s13, 0xaaaaaaaa
    s_mov_b32 s14, 0x3e0293ee
    s_mov_b32 s74, 0x05040100
    s_mov_b32 s75, 0x07060302
    v_lshlrev_b32 v4, 4, v0
    v_lshl_add_u32 v5, v3, 2, v2
    v_lshlrev_b32 v5, 4, v5
    v_mov_b32 v15, 0xffffff00
    v_mov_b32 v16, 0
    v_mov_b32 v17, 0
    v_mov_b32 v18, 0
    v_mov_b32 v19, 0
    ds_write_b128 v1, v[16:19] offset:4656
    s_and_b32 s8, s4, 7
    s_mov_b32 s43, -4
    s_cmp_eq_u32 s8, s5
    s_cselect_b32 s43, -18, s43
    s_mov_b32 s15, -9
    v_mov_b32 v20, s43
    v_mov_b32 v21, s43
    v_mov_b32 v22, s43
    v_mov_b32 v23, s43
    ds_write_b128 v1, v[20:23] offset:4688
    v_lshrrev_b32 v11, 1, v4
    v_lshlrev_b32 v12, 2, v0
    v_and_b32 v13, 31, v0
    v_lshlrev_b32 v13, 3, v13
    s_waitcnt lgkmcnt(0)
    s_mov_b32 s60, s40
    s_mov_b32 s61, s41
    s_mov_b32 s62, 1835008
    s_mov_b32 s63, 0x20000
    s_cmp_eq_u32 s3, 5
    s_cbranch_scc1 L_awave
    buffer_load_dword v48, v1, s[60:63], 0 offen sc1
    s_mov_b32 s72, 0
    s_bfe_u32 s8, s5, 0x10000
    s_lshl_b32 s8, s8, 16
    s_xor_b32 s72, s72, s8
    s_bfe_u32 s8, s5, 0x10001
    s_lshl_b32 s8, s8, 21
    s_xor_b32 s72, s72, s8
    s_bfe_u32 s8, s5, 0x10002
    s_lshl_b32 s8, s8, 14
    s_xor_b32 s72, s72, s8
    s_lshl_b32 s8, s4, 23
    s_add_u32 s8, s8, s72
    s_load_dword s72, s[28:29], s8
    s_barrier
    s_waitcnt vmcnt(0) lgkmcnt(0)
    v_readfirstlane_b32 s42, v48
    s_nop 0
    s_add_u32 s6, s42, 1
    s_and_b32 s6, s6, 0xff
    s_and_b32 s8, s5, 1
    s_mul_i32 s79, s8, 131072
    s_lshl_b32 s9, s4, 11
    s_add_u32 s9, s9, 65536
    s_add_u32 s79, s79, s9
    s_lshr_b32 s8, s5, 1
    s_lshl_b32 s8, s8, 9
    s_add_u32 s79, s79, s8
    s_mov_b32 s76, 2000000
L_lw100:
    ds_read_b32 v42, v1 offset:4660
    s_waitcnt lgkmcnt(0)
    v_readfirstlane_b32 s8, v42
    s_nop 0
    s_cmp_ge_u32 s8, 4
    s_cbranch_scc1 L_lwd100
    s_sub_u32 s76, s76, 1
    s_cbranch_scc1 L_lwd100
    s_sleep 1
    s_branch L_lw100
L_lwd100:
    ds_read_b64 v[44:45], v11 offset:0
    ds_read_b64 v[46:47], v11 offset:512
    ds_read_b64 v[48:49], v11 offset:1024
    ds_read_b64 v[50:51], v11 offset:1536
    s_waitcnt lgkmcnt(0)
    v_add_f32 v44, v44, v46
    v_add_f32 v45, v45, v47
    v_add_f32 v48, v48, v50
    v_add_f32 v49, v49, v51
    v_add_f32 v52, v44, v48
    v_add_f32 v53, v45, v49
    v_add_u32 v52, 0x80, v52
    v_add_u32 v53, 0x80, v53
    v_and_or_b32 v52, v52, v15, s6
    v_and_or_b32 v53, v53, v15, s6
    buffer_store_dwordx2 v[52:53], v11, s[60:63], s79 offen sc1
    s_mov_b32 s76, 2000000
L_poll101:
    s_sleep 12
    buffer_load_dwordx4 v[64:67], v4, s[60:63], s9 offen offset:0 sc1
    buffer_load_dwordx4 v[68:71], v4, s[60:63], s9 offen offset:1024 sc1
    s_waitcnt vmcnt(0)
    v_bitop3_b32 v42, v64, v65, s6 bitop3:0x7e
    v_bitop3_b32 v43, v66, v67, s6 bitop3:0x7e
    v_bitop3_b32 v41, v68, v69, s6 bitop3:0x7e
    v_or3_b32 v42, v42, v43, v41
    v_bitop3_b32 v43, v70, v71, s6 bitop3:0x7e
    v_or_b32 v42, v42, v43
    v_and_b32 v42, 0xff, v42
    v_cmp_ne_u32 vcc, 0, v42
    s_nop 0
    s_cmp_eq_u64 vcc, 0
    s_cbranch_scc1 L_polld101
    s_sub_u32 s76, s76, 1
    s_cbranch_scc1 L_polld101
    s_branch L_poll101
L_polld101:
    v_and_b32 v64, v64, v15
    v_and_b32 v65, v65, v15
    v_and_b32 v66, v66, v15
    v_and_b32 v67, v67, v15
    v_and_b32 v68, v68, v15
    v_and_b32 v69, v69, v15
    v_and_b32 v70, v70, v15
    v_and_b32 v71, v71, v15
    v_add_f32 v64, v64, v68
    v_add_f32 v65, v65, v69
    v_add_f32 v66, v66, v70
    v_add_f32 v67, v67, v71
    v_mov_b32 v68, v64
    v_mov_b32 v69, v65
    v_mov_b32 v70, v66
    v_mov_b32 v71, v67
    v_permlane32_swap_b32 v64, v68
    v_permlane32_swap_b32 v65, v69
    v_permlane32_swap_b32 v66, v70
    v_permlane32_swap_b32 v67, v71
    v_add_f32 v64, v64, v68
    v_add_f32 v65, v65, v69
    v_add_f32 v66, v66, v70
    v_add_f32 v67, v67, v71
    v_cvt_pk_bf16_f32 v44, v64, v65
    v_cvt_pk_bf16_f32 v45, v66, v67
    ds_write_b64 v13, v[44:45] offset:4096
    s_or_b32 s8, s6, 0x100
    v_mov_b32 v46, s8
    ds_write_b32 v1, v46 offset:4668
    v_and_b32 v9, 3, v0
    v_lshlrev_b32 v9, 2, v9
    v_lshlrev_b32 v14, 11, v6
    v_mov_b32 v28, 0
    s_lshl_b32 s79, s2, 11
    s_add_u32 s79, s79, 1048576
    s_lshl_b32 s73, s4, 14
    s_add_u32 s73, s73, 1048576
    s_mov_b32 s76, 2000000
L_lw102:
    ds_read_b32 v42, v1 offset:4656
    s_waitcnt lgkmcnt(0)
    v_readfirstlane_b32 s8, v42
    s_nop 0
    s_cmp_ge_u32 s8, 24
    s_cbranch_scc1 L_lwd102
    s_sub_u32 s76, s76, 1
    s_cbranch_scc1 L_lwd102
    s_sleep 4
    s_branch L_lw102
L_lwd102:
    ds_read_b32 v24, v9 offset:4784
    s_waitcnt lgkmcnt(0)
    v_readfirstlane_b32 s8, v24
    s_nop 1
    v_subrev_u32 v24, s8, v24
    s_nop 1
    v_add_u32_dpp v25, v24, v24 quad_perm:[1,0,3,2] row_mask:0xf bank_mask:0xf
    s_nop 1
    v_add_u32_dpp v25, v25, v25 quad_perm:[2,3,0,1] row_mask:0xf bank_mask:0xf
    v_ashrrev_i32 v25, 2, v25
    v_sub_u32 v24, v24, v25
    v_add_u32 v25, s8, v25
    v_lshl_or_b32 v25, v25, 8, s6
    v_mov_b32 v26, v25
    v_mov_b32 v27, v25
    s_mov_b64 exec, 1
    buffer_store_dwordx2 v[26:27], v1, s[60:63], s79 offen offset:640 sc1
    s_mov_b64 exec, -1
    v_xor_b32 v29, s5, v6
    v_lshlrev_b32 v29, 2, v29
    v_xor_b32 v29, s4, v29
    v_lshl_add_u32 v29, v29, 3, v6
    v_lshlrev_b32 v29, 11, v29
    s_mov_b32 s77, 1048576
    s_mov_b32 s76, 2000000
L_poll103:
    s_sleep 24
    buffer_load_dwordx2 v[62:63], v29, s[60:63], s77 offen offset:640 sc1
    s_waitcnt vmcnt(0)
    v_bitop3_b32 v42, v62, v63, s6 bitop3:0x7e
    v_and_b32 v42, 0xff, v42
    v_cmp_ne_u32 vcc, 0, v42
    s_nop 0
    s_cmp_eq_u64 vcc, 0
    s_cbranch_scc1 L_polld103
    s_sub_u32 s76, s76, 1
    s_cbranch_scc1 L_polld103
    s_or_b32 s7, vcc_lo, vcc_hi
    s_lshr_b32 s8, s7, 16
    s_or_b32 s7, s7, s8
    s_lshr_b32 s8, s7, 8
    s_or_b32 s7, s7, s8
    s_and_b32 s7, s7, 0xff
    s_mul_i32 s7, s7, 0x01010101
    s_mov_b32 exec_lo, s7
    s_mov_b32 exec_hi, s7
    s_branch L_poll103
L_polld103:
    s_mov_b64 exec, -1
    v_sub_u32 v62, v62, v25
    v_ashrrev_i32 v62, 8, v62
    s_nop 1
    v_add_u32_dpp v62, v62, v62 quad_perm:[1,0,3,2] row_mask:0xf bank_mask:0xf
    s_nop 1
    v_add_u32_dpp v62, v62, v62 quad_perm:[2,3,0,1] row_mask:0xf bank_mask:0xf
    s_nop 1
    v_add_u32_dpp v62, v62, v62 row_half_mirror row_mask:0xf bank_mask:0xf
    v_ashrrev_i32 v62, 3, v62
    v_sub_u32 v62, v62, v24
    v_cvt_f32_i32 v62, v62
    v_mul_f32 v62, 0x3e0f5c29, v62
    v_cvt_i32_f32 v62, v62
    v_add_u32 v62, s43, v62
    v_min_i32 v62, 32, v62
    v_max_i32 v62, -64, v62
    ds_write_b32 v9, v62 offset:4688
    s_mov_b32 s76, 2000000
L_lw104:
    ds_read_b32 v42, v1 offset:4656
    s_waitcnt lgkmcnt(0)
    v_readfirstlane_b32 s8, v42
    s_nop 0
    s_cmp_ge_u32 s8, 36
    s_cbranch_scc1 L_lwd104
    s_sub_u32 s76, s76, 1
    s_cbranch_scc1 L_lwd104
    s_sleep 4
    s_branch L_lw104
L_lwd104:
    ds_read_b32 v24, v9 offset:4832
    s_waitcnt lgkmcnt(0)
    v_readfirstlane_b32 s8, v24
    s_nop 1
    v_subrev_u32 v24, s8, v24
    s_nop 1
    v_add_u32_dpp v25, v24, v24 quad_perm:[1,0,3,2] row_mask:0xf bank_mask:0xf
    s_nop 1
    v_add_u32_dpp v25, v25, v25 quad_perm:[2,3,0,1] row_mask:0xf bank_mask:0xf
    v_ashrrev_i32 v25, 2, v25
    v_sub_u32 v24, v24, v25
    v_add_u32 v25, s8, v25
    v_lshl_or_b32 v25, v25, 8, s6
    s_mov_b32 s76, 2000000
L_lw105:
    ds_read_b32 v42, v1 offset:4664
    s_waitcnt lgkmcnt(0)
    v_readfirstlane_b32 s8, v42
    s_nop 0
    s_cmp_ge_u32 s8, 4
    s_cbranch_scc1 L_lwd105
    s_sub_u32 s76, s76, 1
    s_cbranch_scc1 L_lwd105
    s_sleep 4
    s_branch L_lw105
L_lwd105:
    ds_read_b128 v[16:19], v1 offset:4608
    ds_read_b128 v[20:23], v1 offset:4624
    s_waitcnt lgkmcnt(0)
    v_max3_f32 v44, v16, v18, v20
    v_max_f32 v44, v44, v22
    v_sub_f32 v48, v16, v44
    v_sub_f32 v49, v18, v44
    v_sub_f32 v50, v20, v44
    v_sub_f32 v51, v22, v44
    v_mul_f32 v48, s14, v48
    v_mul_f32 v49, s14, v49
    v_mul_f32 v50, s14, v50
    v_mul_f32 v51, s14, v51
    v_exp_f32 v48, v48
    v_exp_f32 v49, v49
    v_exp_f32 v50, v50
    v_exp_f32 v51, v51
    v_mul_f32 v45, v48, v17
    v_fmac_f32 v45, v49, v19
    v_fmac_f32 v45, v50, v21
    v_fmac_f32 v45, v51, v23
    s_getreg_b32 s78, hwreg(HW_REG_XCC_ID)
    s_and_b32 s78, s78, 0xff
    s_lshl_b32 s78, s78, 8
    s_or_b32 s78, s78, s6
    v_and_b32 v47, 0xff, v44
    v_lshl_or_b32 v47, v47, 16, s78
    v_and_or_b32 v44, v44, v15, s6
    v_and_or_b32 v45, v45, v15, s6
    v_mov_b32 v46, v25
    s_mov_b64 exec, 1
    buffer_store_dwordx4 v[44:47], v1, s[60:63], s79 offen offset:1024 sc1
    s_mov_b64 exec, -1
    s_mov_b32 s76, 2000000
L_poll106:
    s_sleep 24
    buffer_load_dwordx4 v[60:63], v14, s[60:63], s73 offen offset:1024 sc1
    s_waitcnt vmcnt(0)
    v_bitop3_b32 v42, v60, v61, s6 bitop3:0x7e
    v_bitop3_b32 v43, v62, v63, s6 bitop3:0x7e
    v_or_b32 v42, v42, v43
    v_and_b32 v42, 0xff, v42
    v_cmp_ne_u32 vcc, 0, v42
    s_nop 0
    s_cmp_eq_u64 vcc, 0
    s_cbranch_scc1 L_polld106
    s_sub_u32 s76, s76, 1
    s_cbranch_scc1 L_polld106
    s_or_b32 s7, vcc_lo, vcc_hi
    s_lshr_b32 s8, s7, 16
    s_or_b32 s7, s7, s8
    s_lshr_b32 s8, s7, 8
    s_or_b32 s7, s7, s8
    s_and_b32 s7, s7, 0xff
    s_mul_i32 s7, s7, 0x01010101
    s_mov_b32 exec_lo, s7
    s_mov_b32 exec_hi, s7
    s_branch L_poll106
L_polld106:
    s_mov_b64 exec, -1
    v_sub_u32 v62, v62, v25
    v_ashrrev_i32 v62, 8, v62
    s_nop 1
    v_add_u32_dpp v62, v62, v62 quad_perm:[1,0,3,2] row_mask:0xf bank_mask:0xf
    s_nop 1
    v_add_u32_dpp v62, v62, v62 quad_perm:[2,3,0,1] row_mask:0xf bank_mask:0xf
    s_nop 1
    v_add_u32_dpp v62, v62, v62 row_half_mirror row_mask:0xf bank_mask:0xf
    v_ashrrev_i32 v62, 3, v62
    v_sub_u32 v62, v62, v24
    v_cvt_f32_i32 v62, v62
    v_mul_f32 v62, 0x3e0f5c29, v62
    v_cvt_i32_f32 v62, v62
    v_add_u32 v62, s15, v62
    v_min_i32 v62, 32, v62
    v_max_i32 v62, -64, v62
    ds_write_b32 v9, v62 offset:4688
    v_and_b32 v61, v61, v15
    v_lshrrev_b32 v63, 16, v63
    v_and_or_b32 v60, v60, v15, v63
    v_mov_b32 v58, v60
    s_nop 1
    v_max_f32_dpp v58, v58, v58 quad_perm:[1,0,3,2] row_mask:0xf bank_mask:0xf
    s_nop 1
    v_max_f32_dpp v58, v58, v58 quad_perm:[2,3,0,1] row_mask:0xf bank_mask:0xf
    s_nop 1
    v_max_f32_dpp v58, v58, v58 row_half_mirror row_mask:0xf bank_mask:0xf
    v_sub_f32 v56, v60, v58
    v_mul_f32 v56, s14, v56
    v_exp_f32 v56, v56
    s_nop 0
    v_mul_f32 v57, v56, v61
    s_nop 1
    v_add_f32_dpp v57, v57, v57 quad_perm:[1,0,3,2] row_mask:0xf bank_mask:0xf
    s_nop 1
    v_add_f32_dpp v57, v57, v57 quad_perm:[2,3,0,1] row_mask:0xf bank_mask:0xf
    s_nop 1
    v_add_f32_dpp v57, v57, v57 row_half_mirror row_mask:0xf bank_mask:0xf
    v_rcp_f32 v57, v57
    v_sub_f32 v48, v16, v58
    v_sub_f32 v49, v18, v58
    v_sub_f32 v50, v20, v58
    v_sub_f32 v51, v22, v58
    v_mul_f32 v48, s14, v48
    v_mul_f32 v49, s14, v49
    v_mul_f32 v50, s14, v50
    v_mul_f32 v51, s14, v51
    v_exp_f32 v48, v48
    v_exp_f32 v49, v49
    v_exp_f32 v50, v50
    v_exp_f32 v51, v51
    v_mul_f32 v48, v57, v48
    v_mul_f32 v49, v57, v49
    v_mul_f32 v50, v57, v50
    v_mul_f32 v51, v57, v51
    s_mov_b64 exec, 1
    ds_write_b128 v1, v[48:51] offset:4640
    s_mov_b64 exec, -1
    s_mov_b32 s76, 2000000
L_lw107:
    ds_read_b32 v42, v1 offset:4656
    s_waitcnt lgkmcnt(0)
    v_readfirstlane_b32 s8, v42
    s_nop 0
    s_cmp_ge_u32 s8, 44
    s_cbranch_scc1 L_lwd107
    s_sub_u32 s76, s76, 1
    s_cbranch_scc1 L_lwd107
    s_sleep 4
    s_branch L_lw107
L_lwd107:
    ds_read_b32 v24, v9 offset:4864
    s_waitcnt lgkmcnt(0)
    v_readfirstlane_b32 s8, v24
    s_nop 1
    v_subrev_u32 v24, s8, v24
    s_nop 1
    v_add_u32_dpp v25, v24, v24 quad_perm:[1,0,3,2] row_mask:0xf bank_mask:0xf
    s_nop 1
    v_add_u32_dpp v25, v25, v25 quad_perm:[2,3,0,1] row_mask:0xf bank_mask:0xf
    v_ashrrev_i32 v25, 2, v25
    v_sub_u32 v24, v24, v25
    v_add_u32 v25, s8, v25
    v_lshl_or_b32 v25, v25, 8, s6
    v_mov_b32 v26, v25
    v_mov_b32 v27, v25
    s_mov_b64 exec, 1
    buffer_store_dwordx2 v[26:27], v1, s[60:63], s79 offen offset:1280 sc1
    s_mov_b64 exec, -1
    v_xor_b32 v29, s5, v6
    v_lshlrev_b32 v29, 0, v29
    v_xor_b32 v29, s4, v29
    v_lshl_add_u32 v29, v29, 3, v6
    v_lshlrev_b32 v29, 11, v29
    s_mov_b32 s77, 1048576
    s_mov_b32 s76, 2000000
L_poll108:
    s_sleep 24
    buffer_load_dwordx2 v[62:63], v29, s[60:63], s77 offen offset:1280 sc1
    s_waitcnt vmcnt(0)
    v_bitop3_b32 v42, v62, v63, s6 bitop3:0x7e
    v_and_b32 v42, 0xff, v42
    v_cmp_ne_u32 vcc, 0, v42
    s_nop 0
    s_cmp_eq_u64 vcc, 0
    s_cbranch_scc1 L_polld108
    s_sub_u32 s76, s76, 1
    s_cbranch_scc1 L_polld108
    s_or_b32 s7, vcc_lo, vcc_hi
    s_lshr_b32 s8, s7, 16
    s_or_b32 s7, s7, s8
    s_lshr_b32 s8, s7, 8
    s_or_b32 s7, s7, s8
    s_and_b32 s7, s7, 0xff
    s_mul_i32 s7, s7, 0x01010101
    s_mov_b32 exec_lo, s7
    s_mov_b32 exec_hi, s7
    s_branch L_poll108
L_polld108:
    s_mov_b64 exec, -1
    v_sub_u32 v62, v62, v25
    v_ashrrev_i32 v62, 8, v62
    s_nop 1
    v_add_u32_dpp v62, v62, v62 quad_perm:[1,0,3,2] row_mask:0xf bank_mask:0xf
    s_nop 1
    v_add_u32_dpp v62, v62, v62 quad_perm:[2,3,0,1] row_mask:0xf bank_mask:0xf
    s_nop 1
    v_add_u32_dpp v62, v62, v62 row_half_mirror row_mask:0xf bank_mask:0xf
    v_ashrrev_i32 v62, 3, v62
    v_sub_u32 v62, v62, v24
    v_cvt_f32_i32 v62, v62
    v_mul_f32 v62, 0x3e0f5c29, v62
    v_cvt_i32_f32 v62, v62
    v_add_u32 v62, s15, v62
    v_min_i32 v62, 32, v62
    v_max_i32 v62, -64, v62
    ds_write_b32 v9, v62 offset:4688
    s_mov_b32 s76, 2000000
L_lw109:
    ds_read_b32 v42, v1 offset:4656
    s_waitcnt lgkmcnt(0)
    v_readfirstlane_b32 s8, v42
    s_nop 0
    s_cmp_ge_u32 s8, 52
    s_cbranch_scc1 L_lwd109
    s_sub_u32 s76, s76, 1
    s_cbranch_scc1 L_lwd109
    s_sleep 4
    s_branch L_lw109
L_lwd109:
    ds_read_b32 v24, v9 offset:4896
    s_waitcnt lgkmcnt(0)
    v_readfirstlane_b32 s8, v24
    s_nop 1
    v_subrev_u32 v24, s8, v24
    s_nop 1
    v_add_u32_dpp v25, v24, v24 quad_perm:[1,0,3,2] row_mask:0xf bank_mask:0xf
    s_nop 1
    v_add_u32_dpp v25, v25, v25 quad_perm:[2,3,0,1] row_mask:0xf bank_mask:0xf
    v_ashrrev_i32 v25, 2, v25
    v_sub_u32 v24, v24, v25
    v_add_u32 v25, s8, v25
    v_lshl_or_b32 v25, v25, 8, s6
    v_mov_b32 v26, v25
    v_mov_b32 v27, v25
    s_mov_b64 exec, 1
    buffer_store_dwordx2 v[26:27], v1, s[60:63], s79 offen offset:1536 sc1
    s_mov_b64 exec, -1
    v_xor_b32 v29, s5, v6
    v_lshlrev_b32 v29, 2, v29
    v_xor_b32 v29, s4, v29
    v_lshl_add_u32 v29, v29, 3, v6
    v_lshlrev_b32 v29, 11, v29
    s_mov_b32 s77, 1048576
    s_mov_b32 s76, 2000000
L_poll110:
    s_sleep 24
    buffer_load_dwordx2 v[62:63], v29, s[60:63], s77 offen offset:1536 sc1
    s_waitcnt vmcnt(0)
    v_bitop3_b32 v42, v62, v63, s6 bitop3:0x7e
    v_and_b32 v42, 0xff, v42
    v_cmp_ne_u32 vcc, 0, v42
    s_nop 0
    s_cmp_eq_u64 vcc, 0
    s_cbranch_scc1 L_polld110
    s_sub_u32 s76, s76, 1
    s_cbranch_scc1 L_polld110
    s_or_b32 s7, vcc_lo, vcc_hi
    s_lshr_b32 s8, s7, 16
    s_or_b32 s7, s7, s8
    s_lshr_b32 s8, s7, 8
    s_or_b32 s7, s7, s8
    s_and_b32 s7, s7, 0xff
    s_mul_i32 s7, s7, 0x01010101
    s_mov_b32 exec_lo, s7
    s_mov_b32 exec_hi, s7
    s_branch L_poll110
L_polld110:
    s_mov_b64 exec, -1
    v_sub_u32 v62, v62, v25
    v_ashrrev_i32 v62, 8, v62
    s_nop 1
    v_add_u32_dpp v62, v62, v62 quad_perm:[1,0,3,2] row_mask:0xf bank_mask:0xf
    s_nop 1
    v_add_u32_dpp v62, v62, v62 quad_perm:[2,3,0,1] row_mask:0xf bank_mask:0xf
    s_nop 1
    v_add_u32_dpp v62, v62, v62 row_half_mirror row_mask:0xf bank_mask:0xf
    v_ashrrev_i32 v62, 3, v62
    v_sub_u32 v62, v62, v24
    v_cvt_f32_i32 v62, v62
    v_mul_f32 v62, 0x3e0f5c29, v62
    v_cvt_i32_f32 v62, v62
    v_add_u32 v62, s15, v62
    v_min_i32 v62, 32, v62
    v_max_i32 v62, -64, v62
    ds_write_b32 v9, v62 offset:4688
    s_mov_b32 s76, 2000000
L_lw111:
    ds_read_b32 v42, v1 offset:4656
    s_waitcnt lgkmcnt(0)
    v_readfirstlane_b32 s8, v42
    s_nop 0
    s_cmp_ge_u32 s8, 52
    s_cbranch_scc1 L_lwd111
    s_sub_u32 s76, s76, 1
    s_cbranch_scc1 L_lwd111
    s_sleep 16
    s_branch L_lw111
L_lwd111:
    s_lshl_b32 s9, s4, 13
    s_add_u32 s9, s9, 327680
    s_add_u32 s77, s9, 4096
    v_lshlrev_b32 v13, 10, v6
    s_mov_b32 s76, 2000000
L_poll112:
    buffer_load_dwordx4 v[60:63], v13, s[60:63], s9 offen offset:512 sc1
    buffer_load_dwordx2 v[64:65], v11, s[60:63], s9 offen offset:0 sc1
    buffer_load_dwordx2 v[66:67], v11, s[60:63], s9 offen offset:1024 sc1
    buffer_load_dwordx2 v[68:69], v11, s[60:63], s9 offen offset:2048 sc1
    buffer_load_dwordx2 v[70:71], v11, s[60:63], s9 offen offset:3072 sc1
    buffer_load_dwordx2 v[72:73], v11, s[60:63], s77 offen offset:0 sc1
    buffer_load_dwordx2 v[74:75], v11, s[60:63], s77 offen offset:1024 sc1
    buffer_load_dwordx2 v[76:77], v11, s[60:63], s77 offen offset:2048 sc1
    buffer_load_dwordx2 v[78:79], v11, s[60:63], s77 offen offset:3072 sc1
    s_waitcnt vmcnt(0)
    v_bitop3_b32 v42, v60, v61, s6 bitop3:0x7e
    v_bitop3_b32 v43, v62, v63, s6 bitop3:0x7e
    v_bitop3_b32 v41, v64, v65, s6 bitop3:0x7e
    v_or3_b32 v42, v42, v43, v41
    v_bitop3_b32 v43, v66, v67, s6 bitop3:0x7e
    v_bitop3_b32 v41, v68, v69, s6 bitop3:0x7e
    v_or3_b32 v42, v42, v43, v41
    v_bitop3_b32 v43, v70, v71, s6 bitop3:0x7e
    v_bitop3_b32 v41, v72, v73, s6 bitop3:0x7e
    v_or3_b32 v42, v42, v43, v41
    v_bitop3_b32 v43, v74, v75, s6 bitop3:0x7e
    v_bitop3_b32 v41, v76, v77, s6 bitop3:0x7e
    v_or3_b32 v42, v42, v43, v41
    v_bitop3_b32 v43, v78, v79, s6 bitop3:0x7e
    v_or_b32 v42, v42, v43
    v_and_b32 v42, 0xff, v42
    v_cmp_ne_u32 vcc, 0, v42
    s_nop 0
    s_cmp_eq_u64 vcc, 0
    s_cbranch_scc1 L_polld112
    s_sub_u32 s76, s76, 1
    s_cbranch_scc1 L_polld112
    s_sleep 8
    s_branch L_poll112
L_polld112:
    v_and_b32 v61, v61, v15
    v_and_b32 v64, v64, v15
    v_and_b32 v65, v65, v15
    v_and_b32 v66, v66, v15
    v_and_b32 v67, v67, v15
    v_and_b32 v68, v68, v15
    v_and_b32 v69, v69, v15
    v_and_b32 v70, v70, v15
    v_and_b32 v71, v71, v15
    v_and_b32 v72, v72, v15
    v_and_b32 v73, v73, v15
    v_and_b32 v74, v74, v15
    v_and_b32 v75, v75, v15
    v_and_b32 v76, v76, v15
    v_and_b32 v77, v77, v15
    v_and_b32 v78, v78, v15
    v_and_b32 v79, v79, v15
    v_lshrrev_b32 v62, 8, v62
    v_and_or_b32 v60, v60, v15, v62
    v_mov_b32 v58, v60
    s_nop 1
    v_max_f32_dpp v58, v58, v58 quad_perm:[1,0,3,2] row_mask:0xf bank_mask:0xf
    s_nop 1
    v_max_f32_dpp v58, v58, v58 quad_perm:[2,3,0,1] row_mask:0xf bank_mask:0xf
    s_nop 1
    v_max_f32_dpp v58, v58, v58 row_half_mirror row_mask:0xf bank_mask:0xf
    v_sub_f32 v56, v60, v58
    v_mul_f32 v56, s14, v56
    v_exp_f32 v56, v56
    s_nop 0
    v_mul_f32 v57, v56, v61
    s_nop 1
    v_add_f32_dpp v57, v57, v57 quad_perm:[1,0,3,2] row_mask:0xf bank_mask:0xf
    s_nop 1
    v_add_f32_dpp v57, v57, v57 quad_perm:[2,3,0,1] row_mask:0xf bank_mask:0xf
    s_nop 1
    v_add_f32_dpp v57, v57, v57 row_half_mirror row_mask:0xf bank_mask:0xf
    v_rcp_f32 v57, v57
    s_nop 0
    v_mul_f32 v56, v56, v57
    v_mov_b32 v44, 0
    v_mov_b32 v45, 0
    v_fmac_f32_dpp v44, v56, v64 row_newbcast:0 row_mask:0xf bank_mask:0xf
    v_fmac_f32_dpp v45, v56, v65 row_newbcast:0 row_mask:0xf bank_mask:0xf
    v_fmac_f32_dpp v44, v56, v66 row_newbcast:1 row_mask:0xf bank_mask:0xf
    v_fmac_f32_dpp v45, v56, v67 row_newbcast:1 row_mask:0xf bank_mask:0xf
    v_fmac_f32_dpp v44, v56, v68 row_newbcast:2 row_mask:0xf bank_mask:0xf
    v_fmac_f32_dpp v45, v56, v69 row_newbcast:2 row_mask:0xf bank_mask:0xf
    v_fmac_f32_dpp v44, v56, v70 row_newbcast:3 row_mask:0xf bank_mask:0xf
    v_fmac_f32_dpp v45, v56, v71 row_newbcast:3 row_mask:0xf bank_mask:0xf
    v_fmac_f32_dpp v44, v56, v72 row_newbcast:4 row_mask:0xf bank_mask:0xf
    v_fmac_f32_dpp v45, v56, v73 row_newbcast:4 row_mask:0xf bank_mask:0xf
    v_fmac_f32_dpp v44, v56, v74 row_newbcast:5 row_mask:0xf bank_mask:0xf
    v_fmac_f32_dpp v45, v56, v75 row_newbcast:5 row_mask:0xf bank_mask:0xf
    v_fmac_f32_dpp v44, v56, v76 row_newbcast:6 row_mask:0xf bank_mask:0xf
    v_fmac_f32_dpp v45, v56, v77 row_newbcast:6 row_mask:0xf bank_mask:0xf
    v_fmac_f32_dpp v44, v56, v78 row_newbcast:7 row_mask:0xf bank_mask:0xf
    v_fmac_f32_dpp v45, v56, v79 row_newbcast:7 row_mask:0xf bank_mask:0xf
    v_cvt_pk_bf16_f32 v44, v44, v45
    ds_write_b32 v12, v44 offset:4352
    v_mov_b32 v44, 0
    s_cmp_ge_u32 s4, 8
    s_cbranch_scc1 L_nocol
    v_and_b32 v13, 31, v0
    v_lshlrev_b32 v13, 14, v13
    s_lshl_b32 s9, s5, 11
    s_add_u32 s9, s9, 1048576
    s_mov_b32 s76, 2000000
L_poll113:
    buffer_load_dwordx4 v[60:63], v13, s[60:63], s9 offen offset:1024 sc1
    s_waitcnt vmcnt(0)
    v_bitop3_b32 v42, v60, v61, s6 bitop3:0x7e
    v_bitop3_b32 v43, v62, v63, s6 bitop3:0x7e
    v_or_b32 v42, v42, v43
    v_and_b32 v42, 0xff, v42
    v_cmp_ne_u32 vcc, 0, v42
    s_nop 0
    s_cmp_eq_u64 vcc, 0
    s_cbranch_scc1 L_polld113
    s_sub_u32 s76, s76, 1
    s_cbranch_scc1 L_polld113
    s_sleep 24
    s_branch L_poll113
L_polld113:
    v_and_b32 v63, 0xffff, v63
    v_cmp_ne_u32 vcc, s78, v63
    s_nop 0
    s_cmp_eq_u64 vcc, 0
    s_cselect_b32 s8, 1, 0
    v_mov_b32 v44, s8
L_nocol:
    ds_write_b32 v1, v44 offset:4672
    s_waitcnt lgkmcnt(0)
    s_endpgm
L_awave:
    s_barrier
    s_and_b32 s8, s4, 7
    s_cmp_lg_u32 s8, s5
    s_cbranch_scc1 L_end
    s_mov_b32 s76, 2000000
L_lw114:
    ds_read_b32 v42, v1 offset:4668
    s_waitcnt lgkmcnt(0)
    v_readfirstlane_b32 s8, v42
    s_nop 0
    s_cmp_ge_u32 s8, 1
    s_cbranch_scc1 L_lwd114
    s_sub_u32 s76, s76, 1
    s_cbranch_scc1 L_lwd114
    s_sleep 8
    s_branch L_lw114
L_lwd114:
    s_and_b32 s6, s8, 0xff
    s_lshr_b32 s78, s4, 3
    s_lshl_b32 s9, s78, 14
    s_add_u32 s9, s9, 196608
    s_mov_b32 s15, 2
L_qa:
    s_add_u32 s77, s9, 4096
    s_mov_b32 s76, 2000000
L_poll115:
    buffer_load_dwordx4 v[64:67], v4, s[60:63], s9 offen offset:0 sc1
    buffer_load_dwordx4 v[68:71], v4, s[60:63], s9 offen offset:1024 sc1
    buffer_load_dwordx4 v[72:75], v4, s[60:63], s9 offen offset:2048 sc1
    buffer_load_dwordx4 v[76:79], v4, s[60:63], s9 offen offset:3072 sc1
    buffer_load_dwordx4 v[80:83], v4, s[60:63], s77 offen offset:0 sc1
    buffer_load_dwordx4 v[84:87], v4, s[60:63], s77 offen offset:1024 sc1
    buffer_load_dwordx4 v[88:91], v4, s[60:63], s77 offen offset:2048 sc1
    buffer_load_dwordx4 v[92:95], v4, s[60:63], s77 offen offset:3072 sc1
    s_waitcnt vmcnt(0)
    v_bitop3_b32 v42, v64, v65, s6 bitop3:0x7e
    v_bitop3_b32 v43, v66, v67, s6 bitop3:0x7e
    v_bitop3_b32 v41, v68, v69, s6 bitop3:0x7e
    v_or3_b32 v42, v42, v43, v41
    v_bitop3_b32 v43, v70, v71, s6 bitop3:0x7e
    v_bitop3_b32 v41, v72, v73, s6 bitop3:0x7e
    v_or3_b32 v42, v42, v43, v41
    v_bitop3_b32 v43, v74, v75, s6 bitop3:0x7e
    v_bitop3_b32 v41, v76, v77, s6 bitop3:0x7e
    v_or3_b32 v42, v42, v43, v41
    v_bitop3_b32 v43, v78, v79, s6 bitop3:0x7e
    v_bitop3_b32 v41, v80, v81, s6 bitop3:0x7e
    v_or3_b32 v42, v42, v43, v41
    v_bitop3_b32 v43, v82, v83, s6 bitop3:0x7e
    v_bitop3_b32 v41, v84, v85, s6 bitop3:0x7e
    v_or3_b32 v42, v42, v43, v41
    v_bitop3_b32 v43, v86, v87, s6 bitop3:0x7e
    v_bitop3_b32 v41, v88, v89, s6 bitop3:0x7e
    v_or3_b32 v42, v42, v43, v41
    v_bitop3_b32 v43, v90, v91, s6 bitop3:0x7e
    v_bitop3_b32 v41, v92, v93, s6 bitop3:0x7e
    v_or3_b32 v42, v42, v43, v41
    v_bitop3_b32 v43, v94, v95, s6 bitop3:0x7e
    v_or_b32 v42, v42, v43
    v_and_b32 v42, 0xff, v42
    v_cmp_ne_u32 vcc, 0, v42
    s_nop 0
    s_cmp_eq_u64 vcc, 0
    s_cbranch_scc1 L_polld115
    s_sub_u32 s76, s76, 1
    s_cbranch_scc1 L_polld115
    s_sleep 8
    s_branch L_poll115
L_polld115:
    v_and_b32 v64, v64, v15
    v_and_b32 v65, v65, v15
    v_and_b32 v66, v66, v15
    v_and_b32 v67, v67, v15
    v_and_b32 v68, v68, v15
    v_and_b32 v69, v69, v15
    v_and_b32 v70, v70, v15
    v_and_b32 v71, v71, v15
    v_add_f32 v64, v64, v68
    v_add_f32 v65, v65, v69
    v_add_f32 v66, v66, v70
    v_add_f32 v67, v67, v71
    v_mov_b32 v68, v64
    v_mov_b32 v69, v65
    v_mov_b32 v70, v66
    v_mov_b32 v71, v67
    v_permlane32_swap_b32 v64, v68
    v_permlane32_swap_b32 v65, v69
    v_permlane32_swap_b32 v66, v70
    v_permlane32_swap_b32 v67, v71
    v_add_f32 v64, v64, v68
    v_add_f32 v65, v65, v69
    v_add_f32 v66, v66, v70
    v_add_f32 v67, v67, v71
    v_cvt_pk_bf16_f32 v44, v64, v65
    v_cvt_pk_bf16_f32 v45, v66, v67
    ds_write_b64 v13, v[44:45] offset:5120
    v_and_b32 v72, v72, v15
    v_and_b32 v73, v73, v15
    v_and_b32 v74, v74, v15
    v_and_b32 v75, v75, v15
    v_and_b32 v76, v76, v15
    v_and_b32 v77, v77, v15
    v_and_b32 v78, v78, v15
    v_and_b32 v79, v79, v15
    v_add_f32 v72, v72, v76
    v_add_f32 v73, v73, v77
    v_add_f32 v74, v74, v78
    v_add_f32 v75, v75, v79
    v_mov_b32 v76, v72
    v_mov_b32 v77, v73
    v_mov_b32 v78, v74
    v_mov_b32 v79, v75
    v_permlane32_swap_b32 v72, v76
    v_permlane32_swap_b32 v73, v77
    v_permlane32_swap_b32 v74, v78
    v_permlane32_swap_b32 v75, v79
    v_add_f32 v72, v72, v76
    v_add_f32 v73, v73, v77
    v_add_f32 v74, v74, v78
    v_add_f32 v75, v75, v79
    v_cvt_pk_bf16_f32 v46, v72, v73
    v_cvt_pk_bf16_f32 v47, v74, v75
    ds_write_b64 v13, v[46:47] offset:5376
    v_and_b32 v80, v80, v15
    v_and_b32 v81, v81, v15
    v_and_b32 v82, v82, v15
    v_and_b32 v83, v83, v15
    v_and_b32 v84, v84, v15
    v_and_b32 v85, v85, v15
    v_and_b32 v86, v86, v15
    v_and_b32 v87, v87, v15
    v_add_f32 v80, v80, v84
    v_add_f32 v81, v81, v85
    v_add_f32 v82, v82, v86
    v_add_f32 v83, v83, v87
    v_mov_b32 v84, v80
    v_mov_b32 v85, v81
    v_mov_b32 v86, v82
    v_mov_b32 v87, v83
    v_permlane32_swap_b32 v80, v84
    v_permlane32_swap_b32 v81, v85
    v_permlane32_swap_b32 v82, v86
    v_permlane32_swap_b32 v83, v87
    v_add_f32 v80, v80, v84
    v_add_f32 v81, v81, v85
    v_add_f32 v82, v82, v86
    v_add_f32 v83, v83, v87
    v_cvt_pk_bf16_f32 v48, v80, v81
    v_cvt_pk_bf16_f32 v49, v82, v83
    ds_write_b64 v13, v[48:49] offset:5632
    v_and_b32 v88, v88, v15
    v_and_b32 v89, v89, v15
    v_and_b32 v90, v90, v15
    v_and_b32 v91, v91, v15
    v_and_b32 v92, v92, v15
    v_and_b32 v93, v93, v15
    v_and_b32 v94, v94, v15
    v_and_b32 v95, v95, v15
    v_add_f32 v88, v88, v92
    v_add_f32 v89, v89, v93
    v_add_f32 v90, v90, v94
    v_add_f32 v91, v91, v95
    v_mov_b32 v92, v88
    v_mov_b32 v93, v89
    v_mov_b32 v94, v90
    v_mov_b32 v95, v91
    v_permlane32_swap_b32 v88, v92
    v_permlane32_swap_b32 v89, v93
    v_permlane32_swap_b32 v90, v94
    v_permlane32_swap_b32 v91, v95
    v_add_f32 v88, v88, v92
    v_add_f32 v89, v89, v93
    v_add_f32 v90, v90, v94
    v_add_f32 v91, v91, v95
    v_cvt_pk_bf16_f32 v50, v88, v89
    v_cvt_pk_bf16_f32 v51, v90, v91
    ds_write_b64 v13, v[50:51] offset:5888
    v_add_u32 v13, 1024, v13
    s_add_u32 s9, s9, 8192
    s_sub_u32 s15, s15, 1
    s_cmp_lg_u32 s15, 0
    s_cbranch_scc1 L_qa
    s_lshl_b32 s7, s78, 23
    s_add_u32 s7, s7, 7340032
    s_lshl_b32 s8, s5, 14
    v_add_u32 v9, s8, v4
    s_add_u32 s44, s18, s7
    s_addc_u32 s45, s19, 0
    s_mov_b32 s46, 1048576
    s_mov_b32 s47, 0x20000
    s_add_u32 s48, s20, s7
    s_addc_u32 s49, s21, 0
    s_mov_b32 s50, 1048576
    s_mov_b32 s51, 0x20000
    v_lshlrev_b32 v13, 4, v3
    s_waitcnt lgkmcnt(0)
    ds_read_b128 v[192:195], v13 offset:5120
    ds_read_b128 v[196:199], v13 offset:5376
    ds_read_b128 v[200:203], v13 offset:5632
    ds_read_b128 v[204:207], v13 offset:5888
    ds_read_b128 v[208:211], v13 offset:6144
    ds_read_b128 v[212:215], v13 offset:6400
    ds_read_b128 v[216:219], v13 offset:6656
    ds_read_b128 v[220:223], v13 offset:6912
    s_mov_b32 s43, 0
    s_mov_b32 s72, 0
    s_waitcnt vmcnt(15)
    buffer_load_dwordx4 v[128:131], v9, s[44:47], s43 offen offset:0 nt
    s_waitcnt vmcnt(15)
    buffer_load_dwordx4 v[132:135], v9, s[44:47], s43 offen offset:1024 nt
    s_waitcnt vmcnt(15)
    buffer_load_dwordx4 v[136:139], v9, s[44:47], s43 offen offset:2048 nt
    s_waitcnt vmcnt(15)
    buffer_load_dwordx4 v[140:143], v9, s[44:47], s43 offen offset:3072 nt
    s_add_u32 s43, s43, 4096
    s_waitcnt vmcnt(15)
    buffer_load_dwordx4 v[144:147], v9, s[44:47], s43 offen offset:0 nt
    s_waitcnt vmcnt(15)
    buffer_load_dwordx4 v[148:151], v9, s[44:47], s43 offen offset:1024 nt
    s_waitcnt vmcnt(15)
    buffer_load_dwordx4 v[152:155], v9, s[44:47], s43 offen offset:2048 nt
    s_waitcnt vmcnt(15)
    buffer_load_dwordx4 v[156:159], v9, s[44:47], s43 offen offset:3072 nt
    s_add_u32 s43, s43, 4096
    s_bitcmp1_b32 s43, 14
    s_cselect_b32 s8, 114688, 0
    s_add_u32 s43, s43, s8
    s_waitcnt vmcnt(15)
    buffer_load_dwordx4 v[160:163], v9, s[48:51], s72 offen offset:0 nt
    s_waitcnt vmcnt(15)
    buffer_load_dwordx4 v[164:167], v9, s[48:51], s72 offen offset:1024 nt
    s_waitcnt vmcnt(15)
    buffer_load_dwordx4 v[168:171], v9, s[48:51], s72 offen offset:2048 nt
    s_waitcnt vmcnt(15)
    buffer_load_dwordx4 v[172:175], v9, s[48:51], s72 offen offset:3072 nt
    s_add_u32 s72, s72, 4096
    s_waitcnt vmcnt(15)
    buffer_load_dwordx4 v[176:179], v9, s[48:51], s72 offen offset:0 nt
    s_waitcnt vmcnt(15)
    buffer_load_dwordx4 v[180:183], v9, s[48:51], s72 offen offset:1024 nt
    s_waitcnt vmcnt(15)
    buffer_load_dwordx4 v[184:187], v9, s[48:51], s72 offen offset:2048 nt
    s_waitcnt vmcnt(15)
    buffer_load_dwordx4 v[188:191], v9, s[48:51], s72 offen offset:3072 nt
    s_add_u32 s72, s72, 4096
    s_bitcmp1_b32 s72, 14
    s_cselect_b32 s8, 114688, 0
    s_add_u32 s72, s72, s8
    v_mov_b32 v64, 0
    v_mov_b32 v65, 0
    v_mov_b32 v66, 0
    v_mov_b32 v67, 0
    v_mov_b32 v68, 0
    v_mov_b32 v69, 0
    v_mov_b32 v70, 0
    v_mov_b32 v71, 0
    v_mov_b32 v72, 0
    v_mov_b32 v73, 0
    v_mov_b32 v74, 0
    v_mov_b32 v75, 0
    v_mov_b32 v76, 0
    v_mov_b32 v77, 0
    v_mov_b32 v78, 0
    v_mov_b32 v79, 0
    v_mov_b32 v80, 0
    v_mov_b32 v81, 0
    v_mov_b32 v82, 0
    v_mov_b32 v83, 0
    v_mov_b32 v84, 0
    v_mov_b32 v85, 0
    v_mov_b32 v86, 0
    v_mov_b32 v87, 0
    v_mov_b32 v88, 0
    v_mov_b32 v89, 0
    v_mov_b32 v90, 0
    v_mov_b32 v91, 0
    v_mov_b32 v92, 0
    v_mov_b32 v93, 0
    v_mov_b32 v94, 0
    v_mov_b32 v95, 0
    v_mov_b32 v96, 0
    v_mov_b32 v97, 0
    v_mov_b32 v98, 0
    v_mov_b32 v99, 0
    v_mov_b32 v100, 0
    v_mov_b32 v101, 0
    v_mov_b32 v102, 0
    v_mov_b32 v103, 0
    v_mov_b32 v104, 0
    v_mov_b32 v105, 0
    v_mov_b32 v106, 0
    v_mov_b32 v107, 0
    v_mov_b32 v108, 0
    v_mov_b32 v109, 0
    v_mov_b32 v110, 0
    v_mov_b32 v111, 0
    v_mov_b32 v112, 0
    v_mov_b32 v113, 0
    v_mov_b32 v114, 0
    v_mov_b32 v115, 0
    v_mov_b32 v116, 0
    v_mov_b32 v117, 0
    v_mov_b32 v118, 0
    v_mov_b32 v119, 0
    v_mov_b32 v120, 0
    v_mov_b32 v121, 0
    v_mov_b32 v122, 0
    v_mov_b32 v123, 0
    v_mov_b32 v124, 0
    v_mov_b32 v125, 0
    v_mov_b32 v126, 0
    v_mov_b32 v127, 0
    v_mov_b32 v28, 0xff800000
    v_mov_b32 v29, 0
    s_mov_b32 s15, 16
    s_waitcnt lgkmcnt(0)
L_attA:
    s_waitcnt vmcnt(8)
    v_dot2_f32_bf16 v32, v128, v192, 0
    v_dot2_f32_bf16 v32, v129, v193, v32
    v_dot2_f32_bf16 v32, v130, v194, v32
    v_dot2_f32_bf16 v32, v131, v195, v32
    v_dot2_f32_bf16 v33, v132, v192, 0
    v_dot2_f32_bf16 v33, v133, v193, v33
    v_dot2_f32_bf16 v33, v134, v194, v33
    v_dot2_f32_bf16 v33, v135, v195, v33
    v_add_f32_dpp v34, v32, v32 row_ror:8 row_mask:0xf bank_mask:0x3
    s_nop 1
    v_add_f32_dpp v34, v33, v33 row_ror:8 row_mask:0xf bank_mask:0xc
    v_dot2_f32_bf16 v32, v128, v208, 0
    v_dot2_f32_bf16 v32, v129, v209, v32
    v_dot2_f32_bf16 v32, v130, v210, v32
    v_dot2_f32_bf16 v32, v131, v211, v32
    v_dot2_f32_bf16 v33, v132, v208, 0
    v_dot2_f32_bf16 v33, v133, v209, v33
    v_dot2_f32_bf16 v33, v134, v210, v33
    v_dot2_f32_bf16 v33, v135, v211, v33
    v_add_f32_dpp v35, v32, v32 row_ror:8 row_mask:0xf bank_mask:0x3
    s_nop 1
    v_add_f32_dpp v35, v33, v33 row_ror:8 row_mask:0xf bank_mask:0xc
    v_add_f32_dpp v36, v34, v34 row_shl:4 row_mask:0xf bank_mask:0x5
    s_nop 0
    v_add_f32_dpp v36, v35, v35 row_shr:4 row_mask:0xf bank_mask:0xa
    v_dot2_f32_bf16 v32, v128, v200, 0
    v_dot2_f32_bf16 v32, v129, v201, v32
    v_dot2_f32_bf16 v32, v130, v202, v32
    v_dot2_f32_bf16 v32, v131, v203, v32
    v_dot2_f32_bf16 v33, v132, v200, 0
    v_dot2_f32_bf16 v33, v133, v201, v33
    v_dot2_f32_bf16 v33, v134, v202, v33
    v_dot2_f32_bf16 v33, v135, v203, v33
    v_add_f32_dpp v34, v32, v32 row_ror:8 row_mask:0xf bank_mask:0x3
    s_nop 1
    v_add_f32_dpp v34, v33, v33 row_ror:8 row_mask:0xf bank_mask:0xc
    v_dot2_f32_bf16 v32, v128, v216, 0
    v_dot2_f32_bf16 v32, v129, v217, v32
    v_dot2_f32_bf16 v32, v130, v218, v32
    v_dot2_f32_bf16 v32, v131, v219, v32
    v_dot2_f32_bf16 v33, v132, v216, 0
    v_dot2_f32_bf16 v33, v133, v217, v33
    v_dot2_f32_bf16 v33, v134, v218, v33
    v_dot2_f32_bf16 v33, v135, v219, v33
    v_add_f32_dpp v35, v32, v32 row_ror:8 row_mask:0xf bank_mask:0x3
    s_nop 1
    v_add_f32_dpp v35, v33, v33 row_ror:8 row_mask:0xf bank_mask:0xc
    v_add_f32_dpp v37, v34, v34 row_shl:4 row_mask:0xf bank_mask:0x5
    s_nop 0
    v_add_f32_dpp v37, v35, v35 row_shr:4 row_mask:0xf bank_mask:0xa
    v_add_f32_dpp v40, v36, v36 quad_perm:[2,3,0,1] row_mask:0xf bank_mask:0xf
    s_nop 0
    v_add_f32_dpp v41, v37, v37 quad_perm:[2,3,0,1] row_mask:0xf bank_mask:0xf
    v_cndmask_b32 v38, v40, v41, s[10:11]
    v_dot2_f32_bf16 v32, v128, v196, 0
    v_dot2_f32_bf16 v32, v129, v197, v32
    v_dot2_f32_bf16 v32, v130, v198, v32
    v_dot2_f32_bf16 v32, v131, v199, v32
    v_dot2_f32_bf16 v33, v132, v196, 0
    v_dot2_f32_bf16 v33, v133, v197, v33
    v_dot2_f32_bf16 v33, v134, v198, v33
    v_dot2_f32_bf16 v33, v135, v199, v33
    v_add_f32_dpp v34, v32, v32 row_ror:8 row_mask:0xf bank_mask:0x3
    s_nop 1
    v_add_f32_dpp v34, v33, v33 row_ror:8 row_mask:0xf bank_mask:0xc
    v_dot2_f32_bf16 v32, v128, v212, 0
    v_dot2_f32_bf16 v32, v129, v213, v32
    v_dot2_f32_bf16 v32, v130, v214, v32
    v_dot2_f32_bf16 v32, v131, v215, v32
    v_dot2_f32_bf16 v33, v132, v212, 0
    v_dot2_f32_bf16 v33, v133, v213, v33
    v_dot2_f32_bf16 v33, v134, v214, v33
    v_dot2_f32_bf16 v33, v135, v215, v33
    v_add_f32_dpp v35, v32, v32 row_ror:8 row_mask:0xf bank_mask:0x3
    s_nop 1
    v_add_f32_dpp v35, v33, v33 row_ror:8 row_mask:0xf bank_mask:0xc
    v_add_f32_dpp v36, v34, v34 row_shl:4 row_mask:0xf bank_mask:0x5
    s_nop 0
    v_add_f32_dpp v36, v35, v35 row_shr:4 row_mask:0xf bank_mask:0xa
    v_dot2_f32_bf16 v32, v128, v204, 0
    v_dot2_f32_bf16 v32, v129, v205, v32
    v_dot2_f32_bf16 v32, v130, v206, v32
    v_dot2_f32_bf16 v32, v131, v207, v32
    v_dot2_f32_bf16 v33, v132, v204, 0
    v_dot2_f32_bf16 v33, v133, v205, v33
    v_dot2_f32_bf16 v33, v134, v206, v33
    v_dot2_f32_bf16 v33, v135, v207, v33
    v_add_f32_dpp v34, v32, v32 row_ror:8 row_mask:0xf bank_mask:0x3
    s_nop 1
    v_add_f32_dpp v34, v33, v33 row_ror:8 row_mask:0xf bank_mask:0xc
    v_dot2_f32_bf16 v32, v128, v220, 0
    v_dot2_f32_bf16 v32, v129, v221, v32
    v_dot2_f32_bf16 v32, v130, v222, v32
    v_dot2_f32_bf16 v32, v131, v223, v32
    v_dot2_f32_bf16 v33, v132, v220, 0
    v_dot2_f32_bf16 v33, v133, v221, v33
    v_dot2_f32_bf16 v33, v134, v222, v33
    v_dot2_f32_bf16 v33, v135, v223, v33
    v_add_f32_dpp v35, v32, v32 row_ror:8 row_mask:0xf bank_mask:0x3
    s_nop 1
    v_add_f32_dpp v35, v33, v33 row_ror:8 row_mask:0xf bank_mask:0xc
    v_add_f32_dpp v37, v34, v34 row_shl:4 row_mask:0xf bank_mask:0x5
    s_nop 0
    v_add_f32_dpp v37, v35, v35 row_shr:4 row_mask:0xf bank_mask:0xa
    v_add_f32_dpp v40, v36, v36 quad_perm:[2,3,0,1] row_mask:0xf bank_mask:0xf
    s_nop 0
    v_add_f32_dpp v41, v37, v37 quad_perm:[2,3,0,1] row_mask:0xf bank_mask:0xf
    v_cndmask_b32 v39, v40, v41, s[10:11]
    v_add_f32_dpp v40, v38, v38 quad_perm:[1,0,3,2] row_mask:0xf bank_mask:0xf
    s_nop 0
    v_add_f32_dpp v41, v39, v39 quad_perm:[1,0,3,2] row_mask:0xf bank_mask:0xf
    v_cndmask_b32 v224, v40, v41, s[12:13]
    v_dot2_f32_bf16 v32, v136, v192, 0
    v_dot2_f32_bf16 v32, v137, v193, v32
    v_dot2_f32_bf16 v32, v138, v194, v32
    v_dot2_f32_bf16 v32, v139, v195, v32
    v_dot2_f32_bf16 v33, v140, v192, 0
    v_dot2_f32_bf16 v33, v141, v193, v33
    v_dot2_f32_bf16 v33, v142, v194, v33
    v_dot2_f32_bf16 v33, v143, v195, v33
    v_add_f32_dpp v34, v32, v32 row_ror:8 row_mask:0xf bank_mask:0x3
    s_nop 1
    v_add_f32_dpp v34, v33, v33 row_ror:8 row_mask:0xf bank_mask:0xc
    v_dot2_f32_bf16 v32, v136, v208, 0
    v_dot2_f32_bf16 v32, v137, v209, v32
    v_dot2_f32_bf16 v32, v138, v210, v32
    v_dot2_f32_bf16 v32, v139, v211, v32
    v_dot2_f32_bf16 v33, v140, v208, 0
    v_dot2_f32_bf16 v33, v141, v209, v33
    v_dot2_f32_bf16 v33, v142, v210, v33
    v_dot2_f32_bf16 v33, v143, v211, v33
    v_add_f32_dpp v35, v32, v32 row_ror:8 row_mask:0xf bank_mask:0x3
    s_nop 1
    v_add_f32_dpp v35, v33, v33 row_ror:8 row_mask:0xf bank_mask:0xc
    v_add_f32_dpp v36, v34, v34 row_shl:4 row_mask:0xf bank_mask:0x5
    s_nop 0
    v_add_f32_dpp v36, v35, v35 row_shr:4 row_mask:0xf bank_mask:0xa
    v_dot2_f32_bf16 v32, v136, v200, 0
    v_dot2_f32_bf16 v32, v137, v201, v32
    v_dot2_f32_bf16 v32, v138, v202, v32
    v_dot2_f32_bf16 v32, v139, v203, v32
    v_dot2_f32_bf16 v33, v140, v200, 0
    v_dot2_f32_bf16 v33, v141, v201, v33
    v_dot2_f32_bf16 v33, v142, v202, v33
    v_dot2_f32_bf16 v33, v143, v203, v33
    v_add_f32_dpp v34, v32, v32 row_ror:8 row_mask:0xf bank_mask:0x3
    s_nop 1
    v_add_f32_dpp v34, v33, v33 row_ror:8 row_mask:0xf bank_mask:0xc
    v_dot2_f32_bf16 v32, v136, v216, 0
    v_dot2_f32_bf16 v32, v137, v217, v32
    v_dot2_f32_bf16 v32, v138, v218, v32
    v_dot2_f32_bf16 v32, v139, v219, v32
    v_dot2_f32_bf16 v33, v140, v216, 0
    v_dot2_f32_bf16 v33, v141, v217, v33
    v_dot2_f32_bf16 v33, v142, v218, v33
    v_dot2_f32_bf16 v33, v143, v219, v33
    v_add_f32_dpp v35, v32, v32 row_ror:8 row_mask:0xf bank_mask:0x3
    s_nop 1
    v_add_f32_dpp v35, v33, v33 row_ror:8 row_mask:0xf bank_mask:0xc
    v_add_f32_dpp v37, v34, v34 row_shl:4 row_mask:0xf bank_mask:0x5
    s_nop 0
    v_add_f32_dpp v37, v35, v35 row_shr:4 row_mask:0xf bank_mask:0xa
    v_add_f32_dpp v40, v36, v36 quad_perm:[2,3,0,1] row_mask:0xf bank_mask:0xf
    s_nop 0
    v_add_f32_dpp v41, v37, v37 quad_perm:[2,3,0,1] row_mask:0xf bank_mask:0xf
    v_cndmask_b32 v38, v40, v41, s[10:11]
    v_dot2_f32_bf16 v32, v136, v196, 0
    v_dot2_f32_bf16 v32, v137, v197, v32
    v_dot2_f32_bf16 v32, v138, v198, v32
    v_dot2_f32_bf16 v32, v139, v199, v32
    v_dot2_f32_bf16 v33, v140, v196, 0
    v_dot2_f32_bf16 v33, v141, v197, v33
    v_dot2_f32_bf16 v33, v142, v198, v33
    v_dot2_f32_bf16 v33, v143, v199, v33
    v_add_f32_dpp v34, v32, v32 row_ror:8 row_mask:0xf bank_mask:0x3
    s_nop 1
    v_add_f32_dpp v34, v33, v33 row_ror:8 row_mask:0xf bank_mask:0xc
    v_dot2_f32_bf16 v32, v136, v212, 0
    v_dot2_f32_bf16 v32, v137, v213, v32
    v_dot2_f32_bf16 v32, v138, v214, v32
    v_dot2_f32_bf16 v32, v139, v215, v32
    v_dot2_f32_bf16 v33, v140, v212, 0
    v_dot2_f32_bf16 v33, v141, v213, v33
    v_dot2_f32_bf16 v33, v142, v214, v33
    v_dot2_f32_bf16 v33, v143, v215, v33
    v_add_f32_dpp v35, v32, v32 row_ror:8 row_mask:0xf bank_mask:0x3
    s_nop 1
    v_add_f32_dpp v35, v33, v33 row_ror:8 row_mask:0xf bank_mask:0xc
    v_add_f32_dpp v36, v34, v34 row_shl:4 row_mask:0xf bank_mask:0x5
    s_nop 0
    v_add_f32_dpp v36, v35, v35 row_shr:4 row_mask:0xf bank_mask:0xa
    v_dot2_f32_bf16 v32, v136, v204, 0
    v_dot2_f32_bf16 v32, v137, v205, v32
    v_dot2_f32_bf16 v32, v138, v206, v32
    v_dot2_f32_bf16 v32, v139, v207, v32
    v_dot2_f32_bf16 v33, v140, v204, 0
    v_dot2_f32_bf16 v33, v141, v205, v33
    v_dot2_f32_bf16 v33, v142, v206, v33
    v_dot2_f32_bf16 v33, v143, v207, v33
    v_add_f32_dpp v34, v32, v32 row_ror:8 row_mask:0xf bank_mask:0x3
    s_nop 1
    v_add_f32_dpp v34, v33, v33 row_ror:8 row_mask:0xf bank_mask:0xc
    v_dot2_f32_bf16 v32, v136, v220, 0
    v_dot2_f32_bf16 v32, v137, v221, v32
    v_dot2_f32_bf16 v32, v138, v222, v32
    v_dot2_f32_bf16 v32, v139, v223, v32
    v_dot2_f32_bf16 v33, v140, v220, 0
    v_dot2_f32_bf16 v33, v141, v221, v33
    v_dot2_f32_bf16 v33, v142, v222, v33
    v_dot2_f32_bf16 v33, v143, v223, v33
    v_add_f32_dpp v35, v32, v32 row_ror:8 row_mask:0xf bank_mask:0x3
    s_nop 1
    v_add_f32_dpp v35, v33, v33 row_ror:8 row_mask:0xf bank_mask:0xc
    v_add_f32_dpp v37, v34, v34 row_shl:4 row_mask:0xf bank_mask:0x5
    s_nop 0
    v_add_f32_dpp v37, v35, v35 row_shr:4 row_mask:0xf bank_mask:0xa
    v_add_f32_dpp v40, v36, v36 quad_perm:[2,3,0,1] row_mask:0xf bank_mask:0xf
    s_nop 0
    v_add_f32_dpp v41, v37, v37 quad_perm:[2,3,0,1] row_mask:0xf bank_mask:0xf
    v_cndmask_b32 v39, v40, v41, s[10:11]
    v_add_f32_dpp v40, v38, v38 quad_perm:[1,0,3,2] row_mask:0xf bank_mask:0xf
    s_nop 0
    v_add_f32_dpp v41, v39, v39 quad_perm:[1,0,3,2] row_mask:0xf bank_mask:0xf
    v_cndmask_b32 v225, v40, v41, s[12:13]
    v_dot2_f32_bf16 v32, v144, v192, 0
    v_dot2_f32_bf16 v32, v145, v193, v32
    v_dot2_f32_bf16 v32, v146, v194, v32
    v_dot2_f32_bf16 v32, v147, v195, v32
    v_dot2_f32_bf16 v33, v148, v192, 0
    v_dot2_f32_bf16 v33, v149, v193, v33
    v_dot2_f32_bf16 v33, v150, v194, v33
    v_dot2_f32_bf16 v33, v151, v195, v33
    v_add_f32_dpp v34, v32, v32 row_ror:8 row_mask:0xf bank_mask:0x3
    s_nop 1
    v_add_f32_dpp v34, v33, v33 row_ror:8 row_mask:0xf bank_mask:0xc
    v_dot2_f32_bf16 v32, v144, v208, 0
    v_dot2_f32_bf16 v32, v145, v209, v32
    v_dot2_f32_bf16 v32, v146, v210, v32
    v_dot2_f32_bf16 v32, v147, v211, v32
    v_dot2_f32_bf16 v33, v148, v208, 0
    v_dot2_f32_bf16 v33, v149, v209, v33
    v_dot2_f32_bf16 v33, v150, v210, v33
    v_dot2_f32_bf16 v33, v151, v211, v33
    v_add_f32_dpp v35, v32, v32 row_ror:8 row_mask:0xf bank_mask:0x3
    s_nop 1
    v_add_f32_dpp v35, v33, v33 row_ror:8 row_mask:0xf bank_mask:0xc
    v_add_f32_dpp v36, v34, v34 row_shl:4 row_mask:0xf bank_mask:0x5
    s_nop 0
    v_add_f32_dpp v36, v35, v35 row_shr:4 row_mask:0xf bank_mask:0xa
    v_dot2_f32_bf16 v32, v144, v200, 0
    v_dot2_f32_bf16 v32, v145, v201, v32
    v_dot2_f32_bf16 v32, v146, v202, v32
    v_dot2_f32_bf16 v32, v147, v203, v32
    v_dot2_f32_bf16 v33, v148, v200, 0
    v_dot2_f32_bf16 v33, v149, v201, v33
    v_dot2_f32_bf16 v33, v150, v202, v33
    v_dot2_f32_bf16 v33, v151, v203, v33
    v_add_f32_dpp v34, v32, v32 row_ror:8 row_mask:0xf bank_mask:0x3
    s_nop 1
    v_add_f32_dpp v34, v33, v33 row_ror:8 row_mask:0xf bank_mask:0xc
    v_dot2_f32_bf16 v32, v144, v216, 0
    v_dot2_f32_bf16 v32, v145, v217, v32
    v_dot2_f32_bf16 v32, v146, v218, v32
    v_dot2_f32_bf16 v32, v147, v219, v32
    v_dot2_f32_bf16 v33, v148, v216, 0
    v_dot2_f32_bf16 v33, v149, v217, v33
    v_dot2_f32_bf16 v33, v150, v218, v33
    v_dot2_f32_bf16 v33, v151, v219, v33
    v_add_f32_dpp v35, v32, v32 row_ror:8 row_mask:0xf bank_mask:0x3
    s_nop 1
    v_add_f32_dpp v35, v33, v33 row_ror:8 row_mask:0xf bank_mask:0xc
    v_add_f32_dpp v37, v34, v34 row_shl:4 row_mask:0xf bank_mask:0x5
    s_nop 0
    v_add_f32_dpp v37, v35, v35 row_shr:4 row_mask:0xf bank_mask:0xa
    v_add_f32_dpp v40, v36, v36 quad_perm:[2,3,0,1] row_mask:0xf bank_mask:0xf
    s_nop 0
    v_add_f32_dpp v41, v37, v37 quad_perm:[2,3,0,1] row_mask:0xf bank_mask:0xf
    v_cndmask_b32 v38, v40, v41, s[10:11]
    v_dot2_f32_bf16 v32, v144, v196, 0
    v_dot2_f32_bf16 v32, v145, v197, v32
    v_dot2_f32_bf16 v32, v146, v198, v32
    v_dot2_f32_bf16 v32, v147, v199, v32
    v_dot2_f32_bf16 v33, v148, v196, 0
    v_dot2_f32_bf16 v33, v149, v197, v33
    v_dot2_f32_bf16 v33, v150, v198, v33
    v_dot2_f32_bf16 v33, v151, v199, v33
    v_add_f32_dpp v34, v32, v32 row_ror:8 row_mask:0xf bank_mask:0x3
    s_nop 1
    v_add_f32_dpp v34, v33, v33 row_ror:8 row_mask:0xf bank_mask:0xc
    v_dot2_f32_bf16 v32, v144, v212, 0
    v_dot2_f32_bf16 v32, v145, v213, v32
    v_dot2_f32_bf16 v32, v146, v214, v32
    v_dot2_f32_bf16 v32, v147, v215, v32
    v_dot2_f32_bf16 v33, v148, v212, 0
    v_dot2_f32_bf16 v33, v149, v213, v33
    v_dot2_f32_bf16 v33, v150, v214, v33
    v_dot2_f32_bf16 v33, v151, v215, v33
    v_add_f32_dpp v35, v32, v32 row_ror:8 row_mask:0xf bank_mask:0x3
    s_nop 1
    v_add_f32_dpp v35, v33, v33 row_ror:8 row_mask:0xf bank_mask:0xc
    v_add_f32_dpp v36, v34, v34 row_shl:4 row_mask:0xf bank_mask:0x5
    s_nop 0
    v_add_f32_dpp v36, v35, v35 row_shr:4 row_mask:0xf bank_mask:0xa
    v_dot2_f32_bf16 v32, v144, v204, 0
    v_dot2_f32_bf16 v32, v145, v205, v32
    v_dot2_f32_bf16 v32, v146, v206, v32
    v_dot2_f32_bf16 v32, v147, v207, v32
    v_dot2_f32_bf16 v33, v148, v204, 0
    v_dot2_f32_bf16 v33, v149, v205, v33
    v_dot2_f32_bf16 v33, v150, v206, v33
    v_dot2_f32_bf16 v33, v151, v207, v33
    v_add_f32_dpp v34, v32, v32 row_ror:8 row_mask:0xf bank_mask:0x3
    s_nop 1
    v_add_f32_dpp v34, v33, v33 row_ror:8 row_mask:0xf bank_mask:0xc
    v_dot2_f32_bf16 v32, v144, v220, 0
    v_dot2_f32_bf16 v32, v145, v221, v32
    v_dot2_f32_bf16 v32, v146, v222, v32
    v_dot2_f32_bf16 v32, v147, v223, v32
    v_dot2_f32_bf16 v33, v148, v220, 0
    v_dot2_f32_bf16 v33, v149, v221, v33
    v_dot2_f32_bf16 v33, v150, v222, v33
    v_dot2_f32_bf16 v33, v151, v223, v33
    v_add_f32_dpp v35, v32, v32 row_ror:8 row_mask:0xf bank_mask:0x3
    s_nop 1
    v_add_f32_dpp v35, v33, v33 row_ror:8 row_mask:0xf bank_mask:0xc
    v_add_f32_dpp v37, v34, v34 row_shl:4 row_mask:0xf bank_mask:0x5
    s_nop 0
    v_add_f32_dpp v37, v35, v35 row_shr:4 row_mask:0xf bank_mask:0xa
    v_add_f32_dpp v40, v36, v36 quad_perm:[2,3,0,1] row_mask:0xf bank_mask:0xf
    s_nop 0
    v_add_f32_dpp v41, v37, v37 quad_perm:[2,3,0,1] row_mask:0xf bank_mask:0xf
    v_cndmask_b32 v39, v40, v41, s[10:11]
    v_add_f32_dpp v40, v38, v38 quad_perm:[1,0,3,2] row_mask:0xf bank_mask:0xf
    s_nop 0
    v_add_f32_dpp v41, v39, v39 quad_perm:[1,0,3,2] row_mask:0xf bank_mask:0xf
    v_cndmask_b32 v226, v40, v41, s[12:13]
    v_dot2_f32_bf16 v32, v152, v192, 0
    v_dot2_f32_bf16 v32, v153, v193, v32
    v_dot2_f32_bf16 v32, v154, v194, v32
    v_dot2_f32_bf16 v32, v155, v195, v32
    v_dot2_f32_bf16 v33, v156, v192, 0
    v_dot2_f32_bf16 v33, v157, v193, v33
    v_dot2_f32_bf16 v33, v158, v194, v33
    v_dot2_f32_bf16 v33, v159, v195, v33
    v_add_f32_dpp v34, v32, v32 row_ror:8 row_mask:0xf bank_mask:0x3
    s_nop 1
    v_add_f32_dpp v34, v33, v33 row_ror:8 row_mask:0xf bank_mask:0xc
    v_dot2_f32_bf16 v32, v152, v208, 0
    v_dot2_f32_bf16 v32, v153, v209, v32
    v_dot2_f32_bf16 v32, v154, v210, v32
    v_dot2_f32_bf16 v32, v155, v211, v32
    v_dot2_f32_bf16 v33, v156, v208, 0
    v_dot2_f32_bf16 v33, v157, v209, v33
    v_dot2_f32_bf16 v33, v158, v210, v33
    v_dot2_f32_bf16 v33, v159, v211, v33
    v_add_f32_dpp v35, v32, v32 row_ror:8 row_mask:0xf bank_mask:0x3
    s_nop 1
    v_add_f32_dpp v35, v33, v33 row_ror:8 row_mask:0xf bank_mask:0xc
    v_add_f32_dpp v36, v34, v34 row_shl:4 row_mask:0xf bank_mask:0x5
    s_nop 0
    v_add_f32_dpp v36, v35, v35 row_shr:4 row_mask:0xf bank_mask:0xa
    v_dot2_f32_bf16 v32, v152, v200, 0
    v_dot2_f32_bf16 v32, v153, v201, v32
    v_dot2_f32_bf16 v32, v154, v202, v32
    v_dot2_f32_bf16 v32, v155, v203, v32
    v_dot2_f32_bf16 v33, v156, v200, 0
    v_dot2_f32_bf16 v33, v157, v201, v33
    v_dot2_f32_bf16 v33, v158, v202, v33
    v_dot2_f32_bf16 v33, v159, v203, v33
    v_add_f32_dpp v34, v32, v32 row_ror:8 row_mask:0xf bank_mask:0x3
    s_nop 1
    v_add_f32_dpp v34, v33, v33 row_ror:8 row_mask:0xf bank_mask:0xc
    v_dot2_f32_bf16 v32, v152, v216, 0
    v_dot2_f32_bf16 v32, v153, v217, v32
    v_dot2_f32_bf16 v32, v154, v218, v32
    v_dot2_f32_bf16 v32, v155, v219, v32
    v_dot2_f32_bf16 v33, v156, v216, 0
    v_dot2_f32_bf16 v33, v157, v217, v33
    v_dot2_f32_bf16 v33, v158, v218, v33
    v_dot2_f32_bf16 v33, v159, v219, v33
    v_add_f32_dpp v35, v32, v32 row_ror:8 row_mask:0xf bank_mask:0x3
    s_nop 1
    v_add_f32_dpp v35, v33, v33 row_ror:8 row_mask:0xf bank_mask:0xc
    v_add_f32_dpp v37, v34, v34 row_shl:4 row_mask:0xf bank_mask:0x5
    s_nop 0
    v_add_f32_dpp v37, v35, v35 row_shr:4 row_mask:0xf bank_mask:0xa
    v_add_f32_dpp v40, v36, v36 quad_perm:[2,3,0,1] row_mask:0xf bank_mask:0xf
    s_nop 0
    v_add_f32_dpp v41, v37, v37 quad_perm:[2,3,0,1] row_mask:0xf bank_mask:0xf
    v_cndmask_b32 v38, v40, v41, s[10:11]
    v_dot2_f32_bf16 v32, v152, v196, 0
    v_dot2_f32_bf16 v32, v153, v197, v32
    v_dot2_f32_bf16 v32, v154, v198, v32
    v_dot2_f32_bf16 v32, v155, v199, v32
    v_dot2_f32_bf16 v33, v156, v196, 0
    v_dot2_f32_bf16 v33, v157, v197, v33
    v_dot2_f32_bf16 v33, v158, v198, v33
    v_dot2_f32_bf16 v33, v159, v199, v33
    v_add_f32_dpp v34, v32, v32 row_ror:8 row_mask:0xf bank_mask:0x3
    s_nop 1
    v_add_f32_dpp v34, v33, v33 row_ror:8 row_mask:0xf bank_mask:0xc
    v_dot2_f32_bf16 v32, v152, v212, 0
    v_dot2_f32_bf16 v32, v153, v213, v32
    v_dot2_f32_bf16 v32, v154, v214, v32
    v_dot2_f32_bf16 v32, v155, v215, v32
    v_dot2_f32_bf16 v33, v156, v212, 0
    v_dot2_f32_bf16 v33, v157, v213, v33
    v_dot2_f32_bf16 v33, v158, v214, v33
    v_dot2_f32_bf16 v33, v159, v215, v33
    v_add_f32_dpp v35, v32, v32 row_ror:8 row_mask:0xf bank_mask:0x3
    s_nop 1
    v_add_f32_dpp v35, v33, v33 row_ror:8 row_mask:0xf bank_mask:0xc
    v_add_f32_dpp v36, v34, v34 row_shl:4 row_mask:0xf bank_mask:0x5
    s_nop 0
    v_add_f32_dpp v36, v35, v35 row_shr:4 row_mask:0xf bank_mask:0xa
    v_dot2_f32_bf16 v32, v152, v204, 0
    v_dot2_f32_bf16 v32, v153, v205, v32
    v_dot2_f32_bf16 v32, v154, v206, v32
    v_dot2_f32_bf16 v32, v155, v207, v32
    v_dot2_f32_bf16 v33, v156, v204, 0
    v_dot2_f32_bf16 v33, v157, v205, v33
    v_dot2_f32_bf16 v33, v158, v206, v33
    v_dot2_f32_bf16 v33, v159, v207, v33
    v_add_f32_dpp v34, v32, v32 row_ror:8 row_mask:0xf bank_mask:0x3
    s_nop 1
    v_add_f32_dpp v34, v33, v33 row_ror:8 row_mask:0xf bank_mask:0xc
    v_dot2_f32_bf16 v32, v152, v220, 0
    v_dot2_f32_bf16 v32, v153, v221, v32
    v_dot2_f32_bf16 v32, v154, v222, v32
    v_dot2_f32_bf16 v32, v155, v223, v32
    v_dot2_f32_bf16 v33, v156, v220, 0
    v_dot2_f32_bf16 v33, v157, v221, v33
    v_dot2_f32_bf16 v33, v158, v222, v33
    v_dot2_f32_bf16 v33, v159, v223, v33
    v_add_f32_dpp v35, v32, v32 row_ror:8 row_mask:0xf bank_mask:0x3
    s_nop 1
    v_add_f32_dpp v35, v33, v33 row_ror:8 row_mask:0xf bank_mask:0xc
    v_add_f32_dpp v37, v34, v34 row_shl:4 row_mask:0xf bank_mask:0x5
    s_nop 0
    v_add_f32_dpp v37, v35, v35 row_shr:4 row_mask:0xf bank_mask:0xa
    v_add_f32_dpp v40, v36, v36 quad_perm:[2,3,0,1] row_mask:0xf bank_mask:0xf
    s_nop 0
    v_add_f32_dpp v41, v37, v37 quad_perm:[2,3,0,1] row_mask:0xf bank_mask:0xf
    v_cndmask_b32 v39, v40, v41, s[10:11]
    v_add_f32_dpp v40, v38, v38 quad_perm:[1,0,3,2] row_mask:0xf bank_mask:0xf
    s_nop 0
    v_add_f32_dpp v41, v39, v39 quad_perm:[1,0,3,2] row_mask:0xf bank_mask:0xf
    v_cndmask_b32 v227, v40, v41, s[12:13]
    s_waitcnt vmcnt(15)
    buffer_load_dwordx4 v[128:131], v9, s[44:47], s43 offen offset:0 nt
    s_waitcnt vmcnt(15)
    buffer_load_dwordx4 v[132:135], v9, s[44:47], s43 offen offset:1024 nt
    s_waitcnt vmcnt(15)
    buffer_load_dwordx4 v[136:139], v9, s[44:47], s43 offen offset:2048 nt
    s_waitcnt vmcnt(15)
    buffer_load_dwordx4 v[140:143], v9, s[44:47], s43 offen offset:3072 nt
    s_add_u32 s43, s43, 4096
    s_waitcnt vmcnt(15)
    buffer_load_dwordx4 v[144:147], v9, s[44:47], s43 offen offset:0 nt
    s_waitcnt vmcnt(15)
    buffer_load_dwordx4 v[148:151], v9, s[44:47], s43 offen offset:1024 nt
    s_waitcnt vmcnt(15)
    buffer_load_dwordx4 v[152:155], v9, s[44:47], s43 offen offset:2048 nt
    s_waitcnt vmcnt(15)
    buffer_load_dwordx4 v[156:159], v9, s[44:47], s43 offen offset:3072 nt
    s_add_u32 s43, s43, 4096
    s_bitcmp1_b32 s43, 14
    s_cselect_b32 s8, 114688, 0
    s_add_u32 s43, s43, s8
    v_max3_f32 v44, v224, v225, v226
    v_max3_f32 v44, v44, v227, v28
    s_nop 1
    v_max_f32_dpp v44, v44, v44 row_ror:8 row_mask:0xf bank_mask:0xf
    v_sub_f32 v45, v28, v44
    v_mov_b32 v28, v44
    v_mul_f32 v45, s14, v45
    v_exp_f32 v45, v45
    v_sub_f32 v224, v224, v44
    v_sub_f32 v225, v225, v44
    v_sub_f32 v226, v226, v44
    v_sub_f32 v227, v227, v44
    v_mul_f32 v224, s14, v224
    v_mul_f32 v225, s14, v225
    v_mul_f32 v226, s14, v226
    v_mul_f32 v227, s14, v227
    v_exp_f32 v224, v224
    v_exp_f32 v225, v225
    v_exp_f32 v226, v226
    v_exp_f32 v227, v227
    v_mul_f32 v29, v45, v29
    v_mov_b32_dpp v228, v224 row_ror:8 row_mask:0xf bank_mask:0xf
    v_mov_b32_dpp v229, v225 row_ror:8 row_mask:0xf bank_mask:0xf
    v_mov_b32_dpp v230, v226 row_ror:8 row_mask:0xf bank_mask:0xf
    v_mov_b32_dpp v231, v227 row_ror:8 row_mask:0xf bank_mask:0xf
    v_add_f32 v29, v29, v224
    v_add_f32 v29, v29, v225
    v_add_f32 v29, v29, v226
    v_add_f32 v29, v29, v227
    v_cvt_pk_bf16_f32 v228, v224, v228
    v_cvt_pk_bf16_f32 v229, v225, v229
    v_cvt_pk_bf16_f32 v230, v226, v230
    v_cvt_pk_bf16_f32 v231, v227, v231
    v_mul_f32_dpp v64, v45, v64 row_newbcast:0 row_mask:0xf bank_mask:0xf
    v_mul_f32_dpp v65, v45, v65 row_newbcast:0 row_mask:0xf bank_mask:0xf
    v_mul_f32_dpp v66, v45, v66 row_newbcast:0 row_mask:0xf bank_mask:0xf
    v_mul_f32_dpp v67, v45, v67 row_newbcast:0 row_mask:0xf bank_mask:0xf
    v_mul_f32_dpp v68, v45, v68 row_newbcast:0 row_mask:0xf bank_mask:0xf
    v_mul_f32_dpp v69, v45, v69 row_newbcast:0 row_mask:0xf bank_mask:0xf
    v_mul_f32_dpp v70, v45, v70 row_newbcast:0 row_mask:0xf bank_mask:0xf
    v_mul_f32_dpp v71, v45, v71 row_newbcast:0 row_mask:0xf bank_mask:0xf
    v_mul_f32_dpp v72, v45, v72 row_newbcast:1 row_mask:0xf bank_mask:0xf
    v_mul_f32_dpp v73, v45, v73 row_newbcast:1 row_mask:0xf bank_mask:0xf
    v_mul_f32_dpp v74, v45, v74 row_newbcast:1 row_mask:0xf bank_mask:0xf
    v_mul_f32_dpp v75, v45, v75 row_newbcast:1 row_mask:0xf bank_mask:0xf
    v_mul_f32_dpp v76, v45, v76 row_newbcast:1 row_mask:0xf bank_mask:0xf
    v_mul_f32_dpp v77, v45, v77 row_newbcast:1 row_mask:0xf bank_mask:0xf
    v_mul_f32_dpp v78, v45, v78 row_newbcast:1 row_mask:0xf bank_mask:0xf
    v_mul_f32_dpp v79, v45, v79 row_newbcast:1 row_mask:0xf bank_mask:0xf
    v_mul_f32_dpp v80, v45, v80 row_newbcast:2 row_mask:0xf bank_mask:0xf
    v_mul_f32_dpp v81, v45, v81 row_newbcast:2 row_mask:0xf bank_mask:0xf
    v_mul_f32_dpp v82, v45, v82 row_newbcast:2 row_mask:0xf bank_mask:0xf
    v_mul_f32_dpp v83, v45, v83 row_newbcast:2 row_mask:0xf bank_mask:0xf
    v_mul_f32_dpp v84, v45, v84 row_newbcast:2 row_mask:0xf bank_mask:0xf
    v_mul_f32_dpp v85, v45, v85 row_newbcast:2 row_mask:0xf bank_mask:0xf
    v_mul_f32_dpp v86, v45, v86 row_newbcast:2 row_mask:0xf bank_mask:0xf
    v_mul_f32_dpp v87, v45, v87 row_newbcast:2 row_mask:0xf bank_mask:0xf
    v_mul_f32_dpp v88, v45, v88 row_newbcast:3 row_mask:0xf bank_mask:0xf
    v_mul_f32_dpp v89, v45, v89 row_newbcast:3 row_mask:0xf bank_mask:0xf
    v_mul_f32_dpp v90, v45, v90 row_newbcast:3 row_mask:0xf bank_mask:0xf
    v_mul_f32_dpp v91, v45, v91 row_newbcast:3 row_mask:0xf bank_mask:0xf
    v_mul_f32_dpp v92, v45, v92 row_newbcast:3 row_mask:0xf bank_mask:0xf
    v_mul_f32_dpp v93, v45, v93 row_newbcast:3 row_mask:0xf bank_mask:0xf
    v_mul_f32_dpp v94, v45, v94 row_newbcast:3 row_mask:0xf bank_mask:0xf
    v_mul_f32_dpp v95, v45, v95 row_newbcast:3 row_mask:0xf bank_mask:0xf
    v_mul_f32_dpp v96, v45, v96 row_newbcast:4 row_mask:0xf bank_mask:0xf
    v_mul_f32_dpp v97, v45, v97 row_newbcast:4 row_mask:0xf bank_mask:0xf
    v_mul_f32_dpp v98, v45, v98 row_newbcast:4 row_mask:0xf bank_mask:0xf
    v_mul_f32_dpp v99, v45, v99 row_newbcast:4 row_mask:0xf bank_mask:0xf
    v_mul_f32_dpp v100, v45, v100 row_newbcast:4 row_mask:0xf bank_mask:0xf
    v_mul_f32_dpp v101, v45, v101 row_newbcast:4 row_mask:0xf bank_mask:0xf
    v_mul_f32_dpp v102, v45, v102 row_newbcast:4 row_mask:0xf bank_mask:0xf
    v_mul_f32_dpp v103, v45, v103 row_newbcast:4 row_mask:0xf bank_mask:0xf
    v_mul_f32_dpp v104, v45, v104 row_newbcast:5 row_mask:0xf bank_mask:0xf
    v_mul_f32_dpp v105, v45, v105 row_newbcast:5 row_mask:0xf bank_mask:0xf
    v_mul_f32_dpp v106, v45, v106 row_newbcast:5 row_mask:0xf bank_mask:0xf
    v_mul_f32_dpp v107, v45, v107 row_newbcast:5 row_mask:0xf bank_mask:0xf
    v_mul_f32_dpp v108, v45, v108 row_newbcast:5 row_mask:0xf bank_mask:0xf
    v_mul_f32_dpp v109, v45, v109 row_newbcast:5 row_mask:0xf bank_mask:0xf
    v_mul_f32_dpp v110, v45, v110 row_newbcast:5 row_mask:0xf bank_mask:0xf
    v_mul_f32_dpp v111, v45, v111 row_newbcast:5 row_mask:0xf bank_mask:0xf
    v_mul_f32_dpp v112, v45, v112 row_newbcast:6 row_mask:0xf bank_mask:0xf
    v_mul_f32_dpp v113, v45, v113 row_newbcast:6 row_mask:0xf bank_mask:0xf
    v_mul_f32_dpp v114, v45, v114 row_newbcast:6 row_mask:0xf bank_mask:0xf
    v_mul_f32_dpp v115, v45, v115 row_newbcast:6 row_mask:0xf bank_mask:0xf
    v_mul_f32_dpp v116, v45, v116 row_newbcast:6 row_mask:0xf bank_mask:0xf
    v_mul_f32_dpp v117, v45, v117 row_newbcast:6 row_mask:0xf bank_mask:0xf
    v_mul_f32_dpp v118, v45, v118 row_newbcast:6 row_mask:0xf bank_mask:0xf
    v_mul_f32_dpp v119, v45, v119 row_newbcast:6 row_mask:0xf bank_mask:0xf
    v_mul_f32_dpp v120, v45, v120 row_newbcast:7 row_mask:0xf bank_mask:0xf
    v_mul_f32_dpp v121, v45, v121 row_newbcast:7 row_mask:0xf bank_mask:0xf
    v_mul_f32_dpp v122, v45, v122 row_newbcast:7 row_mask:0xf bank_mask:0xf
    v_mul_f32_dpp v123, v45, v123 row_newbcast:7 row_mask:0xf bank_mask:0xf
    v_mul_f32_dpp v124, v45, v124 row_newbcast:7 row_mask:0xf bank_mask:0xf
    v_mul_f32_dpp v125, v45, v125 row_newbcast:7 row_mask:0xf bank_mask:0xf
    v_mul_f32_dpp v126, v45, v126 row_newbcast:7 row_mask:0xf bank_mask:0xf
    v_mul_f32_dpp v127, v45, v127 row_newbcast:7 row_mask:0xf bank_mask:0xf
    s_waitcnt vmcnt(8)
    v_perm_b32 v232, v164, v160, s74
    v_perm_b32 v233, v164, v160, s75
    v_perm_b32 v234, v165, v161, s74
    v_perm_b32 v235, v165, v161, s75
    v_perm_b32 v236, v166, v162, s74
    v_perm_b32 v237, v166, v162, s75
    v_perm_b32 v238, v167, v163, s74
    v_perm_b32 v239, v167, v163, s75
    v_dot2c_f32_bf16_dpp v64, v228, v232 row_newbcast:0 row_mask:0xf bank_mask:0xf
    v_dot2c_f32_bf16_dpp v65, v228, v233 row_newbcast:0 row_mask:0xf bank_mask:0xf
    v_dot2c_f32_bf16_dpp v66, v228, v234 row_newbcast:0 row_mask:0xf bank_mask:0xf
    v_dot2c_f32_bf16_dpp v67, v228, v235 row_newbcast:0 row_mask:0xf bank_mask:0xf
    v_dot2c_f32_bf16_dpp v68, v228, v236 row_newbcast:0 row_mask:0xf bank_mask:0xf
    v_dot2c_f32_bf16_dpp v69, v228, v237 row_newbcast:0 row_mask:0xf bank_mask:0xf
    v_dot2c_f32_bf16_dpp v70, v228, v238 row_newbcast:0 row_mask:0xf bank_mask:0xf
    v_dot2c_f32_bf16_dpp v71, v228, v239 row_newbcast:0 row_mask:0xf bank_mask:0xf
    v_dot2c_f32_bf16_dpp v72, v228, v232 row_newbcast:1 row_mask:0xf bank_mask:0xf
    v_dot2c_f32_bf16_dpp v73, v228, v233 row_newbcast:1 row_mask:0xf bank_mask:0xf
    v_dot2c_f32_bf16_dpp v74, v228, v234 row_newbcast:1 row_mask:0xf bank_mask:0xf
    v_dot2c_f32_bf16_dpp v75, v228, v235 row_newbcast:1 row_mask:0xf bank_mask:0xf
    v_dot2c_f32_bf16_dpp v76, v228, v236 row_newbcast:1 row_mask:0xf bank_mask:0xf
    v_dot2c_f32_bf16_dpp v77, v228, v237 row_newbcast:1 row_mask:0xf bank_mask:0xf
    v_dot2c_f32_bf16_dpp v78, v228, v238 row_newbcast:1 row_mask:0xf bank_mask:0xf
    v_dot2c_f32_bf16_dpp v79, v228, v239 row_newbcast:1 row_mask:0xf bank_mask:0xf
    v_dot2c_f32_bf16_dpp v80, v228, v232 row_newbcast:2 row_mask:0xf bank_mask:0xf
    v_dot2c_f32_bf16_dpp v81, v228, v233 row_newbcast:2 row_mask:0xf bank_mask:0xf
    v_dot2c_f32_bf16_dpp v82, v228, v234 row_newbcast:2 row_mask:0xf bank_mask:0xf
    v_dot2c_f32_bf16_dpp v83, v228, v235 row_newbcast:2 row_mask:0xf bank_mask:0xf
    v_dot2c_f32_bf16_dpp v84, v228, v236 row_newbcast:2 row_mask:0xf bank_mask:0xf
    v_dot2c_f32_bf16_dpp v85, v228, v237 row_newbcast:2 row_mask:0xf bank_mask:0xf
    v_dot2c_f32_bf16_dpp v86, v228, v238 row_newbcast:2 row_mask:0xf bank_mask:0xf
    v_dot2c_f32_bf16_dpp v87, v228, v239 row_newbcast:2 row_mask:0xf bank_mask:0xf
    v_dot2c_f32_bf16_dpp v88, v228, v232 row_newbcast:3 row_mask:0xf bank_mask:0xf
    v_dot2c_f32_bf16_dpp v89, v228, v233 row_newbcast:3 row_mask:0xf bank_mask:0xf
    v_dot2c_f32_bf16_dpp v90, v228, v234 row_newbcast:3 row_mask:0xf bank_mask:0xf
    v_dot2c_f32_bf16_dpp v91, v228, v235 row_newbcast:3 row_mask:0xf bank_mask:0xf
    v_dot2c_f32_bf16_dpp v92, v228, v236 row_newbcast:3 row_mask:0xf bank_mask:0xf
    v_dot2c_f32_bf16_dpp v93, v228, v237 row_newbcast:3 row_mask:0xf bank_mask:0xf
    v_dot2c_f32_bf16_dpp v94, v228, v238 row_newbcast:3 row_mask:0xf bank_mask:0xf
    v_dot2c_f32_bf16_dpp v95, v228, v239 row_newbcast:3 row_mask:0xf bank_mask:0xf
    v_dot2c_f32_bf16_dpp v96, v228, v232 row_newbcast:4 row_mask:0xf bank_mask:0xf
    v_dot2c_f32_bf16_dpp v97, v228, v233 row_newbcast:4 row_mask:0xf bank_mask:0xf
    v_dot2c_f32_bf16_dpp v98, v228, v234 row_newbcast:4 row_mask:0xf bank_mask:0xf
    v_dot2c_f32_bf16_dpp v99, v228, v235 row_newbcast:4 row_mask:0xf bank_mask:0xf
    v_dot2c_f32_bf16_dpp v100, v228, v236 row_newbcast:4 row_mask:0xf bank_mask:0xf
    v_dot2c_f32_bf16_dpp v101, v228, v237 row_newbcast:4 row_mask:0xf bank_mask:0xf
    v_dot2c_f32_bf16_dpp v102, v228, v238 row_newbcast:4 row_mask:0xf bank_mask:0xf
    v_dot2c_f32_bf16_dpp v103, v228, v239 row_newbcast:4 row_mask:0xf bank_mask:0xf
    v_dot2c_f32_bf16_dpp v104, v228, v232 row_newbcast:5 row_mask:0xf bank_mask:0xf
    v_dot2c_f32_bf16_dpp v105, v228, v233 row_newbcast:5 row_mask:0xf bank_mask:0xf
    v_dot2c_f32_bf16_dpp v106, v228, v234 row_newbcast:5 row_mask:0xf bank_mask:0xf
    v_dot2c_f32_bf16_dpp v107, v228, v235 row_newbcast:5 row_mask:0xf bank_mask:0xf
    v_dot2c_f32_bf16_dpp v108, v228, v236 row_newbcast:5 row_mask:0xf bank_mask:0xf
    v_dot2c_f32_bf16_dpp v109, v228, v237 row_newbcast:5 row_mask:0xf bank_mask:0xf
    v_dot2c_f32_bf16_dpp v110, v228, v238 row_newbcast:5 row_mask:0xf bank_mask:0xf
    v_dot2c_f32_bf16_dpp v111, v228, v239 row_newbcast:5 row_mask:0xf bank_mask:0xf
    v_dot2c_f32_bf16_dpp v112, v228, v232 row_newbcast:6 row_mask:0xf bank_mask:0xf
    v_dot2c_f32_bf16_dpp v113, v228, v233 row_newbcast:6 row_mask:0xf bank_mask:0xf
    v_dot2c_f32_bf16_dpp v114, v228, v234 row_newbcast:6 row_mask:0xf bank_mask:0xf
    v_dot2c_f32_bf16_dpp v115, v228, v235 row_newbcast:6 row_mask:0xf bank_mask:0xf
    v_dot2c_f32_bf16_dpp v116, v228, v236 row_newbcast:6 row_mask:0xf bank_mask:0xf
    v_dot2c_f32_bf16_dpp v117, v228, v237 row_newbcast:6 row_mask:0xf bank_mask:0xf
    v_dot2c_f32_bf16_dpp v118, v228, v238 row_newbcast:6 row_mask:0xf bank_mask:0xf
    v_dot2c_f32_bf16_dpp v119, v228, v239 row_newbcast:6 row_mask:0xf bank_mask:0xf
    v_dot2c_f32_bf16_dpp v120, v228, v232 row_newbcast:7 row_mask:0xf bank_mask:0xf
    v_dot2c_f32_bf16_dpp v121, v228, v233 row_newbcast:7 row_mask:0xf bank_mask:0xf
    v_dot2c_f32_bf16_dpp v122, v228, v234 row_newbcast:7 row_mask:0xf bank_mask:0xf
    v_dot2c_f32_bf16_dpp v123, v228, v235 row_newbcast:7 row_mask:0xf bank_mask:0xf
    v_dot2c_f32_bf16_dpp v124, v228, v236 row_newbcast:7 row_mask:0xf bank_mask:0xf
    v_dot2c_f32_bf16_dpp v125, v228, v237 row_newbcast:7 row_mask:0xf bank_mask:0xf
    v_dot2c_f32_bf16_dpp v126, v228, v238 row_newbcast:7 row_mask:0xf bank_mask:0xf
    v_dot2c_f32_bf16_dpp v127, v228, v239 row_newbcast:7 row_mask:0xf bank_mask:0xf
    v_perm_b32 v232, v172, v168, s74
    v_perm_b32 v233, v172, v168, s75
    v_perm_b32 v234, v173, v169, s74
    v_perm_b32 v235, v173, v169, s75
    v_perm_b32 v236, v174, v170, s74
    v_perm_b32 v237, v174, v170, s75
    v_perm_b32 v238, v175, v171, s74
    v_perm_b32 v239, v175, v171, s75
    v_dot2c_f32_bf16_dpp v64, v229, v232 row_newbcast:0 row_mask:0xf bank_mask:0xf
    v_dot2c_f32_bf16_dpp v65, v229, v233 row_newbcast:0 row_mask:0xf bank_mask:0xf
    v_dot2c_f32_bf16_dpp v66, v229, v234 row_newbcast:0 row_mask:0xf bank_mask:0xf
    v_dot2c_f32_bf16_dpp v67, v229, v235 row_newbcast:0 row_mask:0xf bank_mask:0xf
    v_dot2c_f32_bf16_dpp v68, v229, v236 row_newbcast:0 row_mask:0xf bank_mask:0xf
    v_dot2c_f32_bf16_dpp v69, v229, v237 row_newbcast:0 row_mask:0xf bank_mask:0xf
    v_dot2c_f32_bf16_dpp v70, v229, v238 row_newbcast:0 row_mask:0xf bank_mask:0xf
    v_dot2c_f32_bf16_dpp v71, v229, v239 row_newbcast:0 row_mask:0xf bank_mask:0xf
    v_dot2c_f32_bf16_dpp v72, v229, v232 row_newbcast:1 row_mask:0xf bank_mask:0xf
    v_dot2c_f32_bf16_dpp v73, v229, v233 row_newbcast:1 row_mask:0xf bank_mask:0xf
    v_dot2c_f32_bf16_dpp v74, v229, v234 row_newbcast:1 row_mask:0xf bank_mask:0xf
    v_dot2c_f32_bf16_dpp v75, v229, v235 row_newbcast:1 row_mask:0xf bank_mask:0xf
    v_dot2c_f32_bf16_dpp v76, v229, v236 row_newbcast:1 row_mask:0xf bank_mask:0xf
    v_dot2c_f32_bf16_dpp v77, v229, v237 row_newbcast:1 row_mask:0xf bank_mask:0xf
    v_dot2c_f32_bf16_dpp v78, v229, v238 row_newbcast:1 row_mask:0xf bank_mask:0xf
    v_dot2c_f32_bf16_dpp v79, v229, v239 row_newbcast:1 row_mask:0xf bank_mask:0xf
    v_dot2c_f32_bf16_dpp v80, v229, v232 row_newbcast:2 row_mask:0xf bank_mask:0xf
    v_dot2c_f32_bf16_dpp v81, v229, v233 row_newbcast:2 row_mask:0xf bank_mask:0xf
    v_dot2c_f32_bf16_dpp v82, v229, v234 row_newbcast:2 row_mask:0xf bank_mask:0xf
    v_dot2c_f32_bf16_dpp v83, v229, v235 row_newbcast:2 row_mask:0xf bank_mask:0xf
    v_dot2c_f32_bf16_dpp v84, v229, v236 row_newbcast:2 row_mask:0xf bank_mask:0xf
    v_dot2c_f32_bf16_dpp v85, v229, v237 row_newbcast:2 row_mask:0xf bank_mask:0xf
    v_dot2c_f32_bf16_dpp v86, v229, v238 row_newbcast:2 row_mask:0xf bank_mask:0xf
    v_dot2c_f32_bf16_dpp v87, v229, v239 row_newbcast:2 row_mask:0xf bank_mask:0xf
    v_dot2c_f32_bf16_dpp v88, v229, v232 row_newbcast:3 row_mask:0xf bank_mask:0xf
    v_dot2c_f32_bf16_dpp v89, v229, v233 row_newbcast:3 row_mask:0xf bank_mask:0xf
    v_dot2c_f32_bf16_dpp v90, v229, v234 row_newbcast:3 row_mask:0xf bank_mask:0xf
    v_dot2c_f32_bf16_dpp v91, v229, v235 row_newbcast:3 row_mask:0xf bank_mask:0xf
    v_dot2c_f32_bf16_dpp v92, v229, v236 row_newbcast:3 row_mask:0xf bank_mask:0xf
    v_dot2c_f32_bf16_dpp v93, v229, v237 row_newbcast:3 row_mask:0xf bank_mask:0xf
    v_dot2c_f32_bf16_dpp v94, v229, v238 row_newbcast:3 row_mask:0xf bank_mask:0xf
    v_dot2c_f32_bf16_dpp v95, v229, v239 row_newbcast:3 row_mask:0xf bank_mask:0xf
    v_dot2c_f32_bf16_dpp v96, v229, v232 row_newbcast:4 row_mask:0xf bank_mask:0xf
    v_dot2c_f32_bf16_dpp v97, v229, v233 row_newbcast:4 row_mask:0xf bank_mask:0xf
    v_dot2c_f32_bf16_dpp v98, v229, v234 row_newbcast:4 row_mask:0xf bank_mask:0xf
    v_dot2c_f32_bf16_dpp v99, v229, v235 row_newbcast:4 row_mask:0xf bank_mask:0xf
    v_dot2c_f32_bf16_dpp v100, v229, v236 row_newbcast:4 row_mask:0xf bank_mask:0xf
    v_dot2c_f32_bf16_dpp v101, v229, v237 row_newbcast:4 row_mask:0xf bank_mask:0xf
    v_dot2c_f32_bf16_dpp v102, v229, v238 row_newbcast:4 row_mask:0xf bank_mask:0xf
    v_dot2c_f32_bf16_dpp v103, v229, v239 row_newbcast:4 row_mask:0xf bank_mask:0xf
    v_dot2c_f32_bf16_dpp v104, v229, v232 row_newbcast:5 row_mask:0xf bank_mask:0xf
    v_dot2c_f32_bf16_dpp v105, v229, v233 row_newbcast:5 row_mask:0xf bank_mask:0xf
    v_dot2c_f32_bf16_dpp v106, v229, v234 row_newbcast:5 row_mask:0xf bank_mask:0xf
    v_dot2c_f32_bf16_dpp v107, v229, v235 row_newbcast:5 row_mask:0xf bank_mask:0xf
    v_dot2c_f32_bf16_dpp v108, v229, v236 row_newbcast:5 row_mask:0xf bank_mask:0xf
    v_dot2c_f32_bf16_dpp v109, v229, v237 row_newbcast:5 row_mask:0xf bank_mask:0xf
    v_dot2c_f32_bf16_dpp v110, v229, v238 row_newbcast:5 row_mask:0xf bank_mask:0xf
    v_dot2c_f32_bf16_dpp v111, v229, v239 row_newbcast:5 row_mask:0xf bank_mask:0xf
    v_dot2c_f32_bf16_dpp v112, v229, v232 row_newbcast:6 row_mask:0xf bank_mask:0xf
    v_dot2c_f32_bf16_dpp v113, v229, v233 row_newbcast:6 row_mask:0xf bank_mask:0xf
    v_dot2c_f32_bf16_dpp v114, v229, v234 row_newbcast:6 row_mask:0xf bank_mask:0xf
    v_dot2c_f32_bf16_dpp v115, v229, v235 row_newbcast:6 row_mask:0xf bank_mask:0xf
    v_dot2c_f32_bf16_dpp v116, v229, v236 row_newbcast:6 row_mask:0xf bank_mask:0xf
    v_dot2c_f32_bf16_dpp v117, v229, v237 row_newbcast:6 row_mask:0xf bank_mask:0xf
    v_dot2c_f32_bf16_dpp v118, v229, v238 row_newbcast:6 row_mask:0xf bank_mask:0xf
    v_dot2c_f32_bf16_dpp v119, v229, v239 row_newbcast:6 row_mask:0xf bank_mask:0xf
    v_dot2c_f32_bf16_dpp v120, v229, v232 row_newbcast:7 row_mask:0xf bank_mask:0xf
    v_dot2c_f32_bf16_dpp v121, v229, v233 row_newbcast:7 row_mask:0xf bank_mask:0xf
    v_dot2c_f32_bf16_dpp v122, v229, v234 row_newbcast:7 row_mask:0xf bank_mask:0xf
    v_dot2c_f32_bf16_dpp v123, v229, v235 row_newbcast:7 row_mask:0xf bank_mask:0xf
    v_dot2c_f32_bf16_dpp v124, v229, v236 row_newbcast:7 row_mask:0xf bank_mask:0xf
    v_dot2c_f32_bf16_dpp v125, v229, v237 row_newbcast:7 row_mask:0xf bank_mask:0xf
    v_dot2c_f32_bf16_dpp v126, v229, v238 row_newbcast:7 row_mask:0xf bank_mask:0xf
    v_dot2c_f32_bf16_dpp v127, v229, v239 row_newbcast:7 row_mask:0xf bank_mask:0xf
    v_perm_b32 v232, v180, v176, s74
    v_perm_b32 v233, v180, v176, s75
    v_perm_b32 v234, v181, v177, s74
    v_perm_b32 v235, v181, v177, s75
    v_perm_b32 v236, v182, v178, s74
    v_perm_b32 v237, v182, v178, s75
    v_perm_b32 v238, v183, v179, s74
    v_perm_b32 v239, v183, v179, s75
    v_dot2c_f32_bf16_dpp v64, v230, v232 row_newbcast:0 row_mask:0xf bank_mask:0xf
    v_dot2c_f32_bf16_dpp v65, v230, v233 row_newbcast:0 row_mask:0xf bank_mask:0xf
    v_dot2c_f32_bf16_dpp v66, v230, v234 row_newbcast:0 row_mask:0xf bank_mask:0xf
    v_dot2c_f32_bf16_dpp v67, v230, v235 row_newbcast:0 row_mask:0xf bank_mask:0xf
    v_dot2c_f32_bf16_dpp v68, v230, v236 row_newbcast:0 row_mask:0xf bank_mask:0xf
    v_dot2c_f32_bf16_dpp v69, v230, v237 row_newbcast:0 row_mask:0xf bank_mask:0xf
    v_dot2c_f32_bf16_dpp v70, v230, v238 row_newbcast:0 row_mask:0xf bank_mask:0xf
    v_dot2c_f32_bf16_dpp v71, v230, v239 row_newbcast:0 row_mask:0xf bank_mask:0xf
    v_dot2c_f32_bf16_dpp v72, v230, v232 row_newbcast:1 row_mask:0xf bank_mask:0xf
    v_dot2c_f32_bf16_dpp v73, v230, v233 row_newbcast:1 row_mask:0xf bank_mask:0xf
    v_dot2c_f32_bf16_dpp v74, v230, v234 row_newbcast:1 row_mask:0xf bank_mask:0xf
    v_dot2c_f32_bf16_dpp v75, v230, v235 row_newbcast:1 row_mask:0xf bank_mask:0xf
    v_dot2c_f32_bf16_dpp v76, v230, v236 row_newbcast:1 row_mask:0xf bank_mask:0xf
    v_dot2c_f32_bf16_dpp v77, v230, v237 row_newbcast:1 row_mask:0xf bank_mask:0xf
    v_dot2c_f32_bf16_dpp v78, v230, v238 row_newbcast:1 row_mask:0xf bank_mask:0xf
    v_dot2c_f32_bf16_dpp v79, v230, v239 row_newbcast:1 row_mask:0xf bank_mask:0xf
    v_dot2c_f32_bf16_dpp v80, v230, v232 row_newbcast:2 row_mask:0xf bank_mask:0xf
    v_dot2c_f32_bf16_dpp v81, v230, v233 row_newbcast:2 row_mask:0xf bank_mask:0xf
    v_dot2c_f32_bf16_dpp v82, v230, v234 row_newbcast:2 row_mask:0xf bank_mask:0xf
    v_dot2c_f32_bf16_dpp v83, v230, v235 row_newbcast:2 row_mask:0xf bank_mask:0xf
    v_dot2c_f32_bf16_dpp v84, v230, v236 row_newbcast:2 row_mask:0xf bank_mask:0xf
    v_dot2c_f32_bf16_dpp v85, v230, v237 row_newbcast:2 row_mask:0xf bank_mask:0xf
    v_dot2c_f32_bf16_dpp v86, v230, v238 row_newbcast:2 row_mask:0xf bank_mask:0xf
    v_dot2c_f32_bf16_dpp v87, v230, v239 row_newbcast:2 row_mask:0xf bank_mask:0xf
    v_dot2c_f32_bf16_dpp v88, v230, v232 row_newbcast:3 row_mask:0xf bank_mask:0xf
    v_dot2c_f32_bf16_dpp v89, v230, v233 row_newbcast:3 row_mask:0xf bank_mask:0xf
    v_dot2c_f32_bf16_dpp v90, v230, v234 row_newbcast:3 row_mask:0xf bank_mask:0xf
    v_dot2c_f32_bf16_dpp v91, v230, v235 row_newbcast:3 row_mask:0xf bank_mask:0xf
    v_dot2c_f32_bf16_dpp v92, v230, v236 row_newbcast:3 row_mask:0xf bank_mask:0xf
    v_dot2c_f32_bf16_dpp v93, v230, v237 row_newbcast:3 row_mask:0xf bank_mask:0xf
    v_dot2c_f32_bf16_dpp v94, v230, v238 row_newbcast:3 row_mask:0xf bank_mask:0xf
    v_dot2c_f32_bf16_dpp v95, v230, v239 row_newbcast:3 row_mask:0xf bank_mask:0xf
    v_dot2c_f32_bf16_dpp v96, v230, v232 row_newbcast:4 row_mask:0xf bank_mask:0xf
    v_dot2c_f32_bf16_dpp v97, v230, v233 row_newbcast:4 row_mask:0xf bank_mask:0xf
    v_dot2c_f32_bf16_dpp v98, v230, v234 row_newbcast:4 row_mask:0xf bank_mask:0xf
    v_dot2c_f32_bf16_dpp v99, v230, v235 row_newbcast:4 row_mask:0xf bank_mask:0xf
    v_dot2c_f32_bf16_dpp v100, v230, v236 row_newbcast:4 row_mask:0xf bank_mask:0xf
    v_dot2c_f32_bf16_dpp v101, v230, v237 row_newbcast:4 row_mask:0xf bank_mask:0xf
    v_dot2c_f32_bf16_dpp v102, v230, v238 row_newbcast:4 row_mask:0xf bank_mask:0xf
    v_dot2c_f32_bf16_dpp v103, v230, v239 row_newbcast:4 row_mask:0xf bank_mask:0xf
    v_dot2c_f32_bf16_dpp v104, v230, v232 row_newbcast:5 row_mask:0xf bank_mask:0xf
    v_dot2c_f32_bf16_dpp v105, v230, v233 row_newbcast:5 row_mask:0xf bank_mask:0xf
    v_dot2c_f32_bf16_dpp v106, v230, v234 row_newbcast:5 row_mask:0xf bank_mask:0xf
    v_dot2c_f32_bf16_dpp v107, v230, v235 row_newbcast:5 row_mask:0xf bank_mask:0xf
    v_dot2c_f32_bf16_dpp v108, v230, v236 row_newbcast:5 row_mask:0xf bank_mask:0xf
    v_dot2c_f32_bf16_dpp v109, v230, v237 row_newbcast:5 row_mask:0xf bank_mask:0xf
    v_dot2c_f32_bf16_dpp v110, v230, v238 row_newbcast:5 row_mask:0xf bank_mask:0xf
    v_dot2c_f32_bf16_dpp v111, v230, v239 row_newbcast:5 row_mask:0xf bank_mask:0xf
    v_dot2c_f32_bf16_dpp v112, v230, v232 row_newbcast:6 row_mask:0xf bank_mask:0xf
    v_dot2c_f32_bf16_dpp v113, v230, v233 row_newbcast:6 row_mask:0xf bank_mask:0xf
    v_dot2c_f32_bf16_dpp v114, v230, v234 row_newbcast:6 row_mask:0xf bank_mask:0xf
    v_dot2c_f32_bf16_dpp v115, v230, v235 row_newbcast:6 row_mask:0xf bank_mask:0xf
    v_dot2c_f32_bf16_dpp v116, v230, v236 row_newbcast:6 row_mask:0xf bank_mask:0xf
    v_dot2c_f32_bf16_dpp v117, v230, v237 row_newbcast:6 row_mask:0xf bank_mask:0xf
    v_dot2c_f32_bf16_dpp v118, v230, v238 row_newbcast:6 row_mask:0xf bank_mask:0xf
    v_dot2c_f32_bf16_dpp v119, v230, v239 row_newbcast:6 row_mask:0xf bank_mask:0xf
    v_dot2c_f32_bf16_dpp v120, v230, v232 row_newbcast:7 row_mask:0xf bank_mask:0xf
    v_dot2c_f32_bf16_dpp v121, v230, v233 row_newbcast:7 row_mask:0xf bank_mask:0xf
    v_dot2c_f32_bf16_dpp v122, v230, v234 row_newbcast:7 row_mask:0xf bank_mask:0xf
    v_dot2c_f32_bf16_dpp v123, v230, v235 row_newbcast:7 row_mask:0xf bank_mask:0xf
    v_dot2c_f32_bf16_dpp v124, v230, v236 row_newbcast:7 row_mask:0xf bank_mask:0xf
    v_dot2c_f32_bf16_dpp v125, v230, v237 row_newbcast:7 row_mask:0xf bank_mask:0xf
    v_dot2c_f32_bf16_dpp v126, v230, v238 row_newbcast:7 row_mask:0xf bank_mask:0xf
    v_dot2c_f32_bf16_dpp v127, v230, v239 row_newbcast:7 row_mask:0xf bank_mask:0xf
    v_perm_b32 v232, v188, v184, s74
    v_perm_b32 v233, v188, v184, s75
    v_perm_b32 v234, v189, v185, s74
    v_perm_b32 v235, v189, v185, s75
    v_perm_b32 v236, v190, v186, s74
    v_perm_b32 v237, v190, v186, s75
    v_perm_b32 v238, v191, v187, s74
    v_perm_b32 v239, v191, v187, s75
    s_waitcnt vmcnt(15)
    buffer_load_dwordx4 v[160:163], v9, s[48:51], s72 offen offset:0 nt
    s_waitcnt vmcnt(15)
    buffer_load_dwordx4 v[164:167], v9, s[48:51], s72 offen offset:1024 nt
    s_waitcnt vmcnt(15)
    buffer_load_dwordx4 v[168:171], v9, s[48:51], s72 offen offset:2048 nt
    s_waitcnt vmcnt(15)
    buffer_load_dwordx4 v[172:175], v9, s[48:51], s72 offen offset:3072 nt
    s_add_u32 s72, s72, 4096
    s_waitcnt vmcnt(15)
    buffer_load_dwordx4 v[176:179], v9, s[48:51], s72 offen offset:0 nt
    s_waitcnt vmcnt(15)
    buffer_load_dwordx4 v[180:183], v9, s[48:51], s72 offen offset:1024 nt
    s_waitcnt vmcnt(15)
    buffer_load_dwordx4 v[184:187], v9, s[48:51], s72 offen offset:2048 nt
    s_waitcnt vmcnt(15)
    buffer_load_dwordx4 v[188:191], v9, s[48:51], s72 offen offset:3072 nt
    s_add_u32 s72, s72, 4096
    s_bitcmp1_b32 s72, 14
    s_cselect_b32 s8, 114688, 0
    s_add_u32 s72, s72, s8
    v_dot2c_f32_bf16_dpp v64, v231, v232 row_newbcast:0 row_mask:0xf bank_mask:0xf
    v_dot2c_f32_bf16_dpp v65, v231, v233 row_newbcast:0 row_mask:0xf bank_mask:0xf
    v_dot2c_f32_bf16_dpp v66, v231, v234 row_newbcast:0 row_mask:0xf bank_mask:0xf
    v_dot2c_f32_bf16_dpp v67, v231, v235 row_newbcast:0 row_mask:0xf bank_mask:0xf
    v_dot2c_f32_bf16_dpp v68, v231, v236 row_newbcast:0 row_mask:0xf bank_mask:0xf
    v_dot2c_f32_bf16_dpp v69, v231, v237 row_newbcast:0 row_mask:0xf bank_mask:0xf
    v_dot2c_f32_bf16_dpp v70, v231, v238 row_newbcast:0 row_mask:0xf bank_mask:0xf
    v_dot2c_f32_bf16_dpp v71, v231, v239 row_newbcast:0 row_mask:0xf bank_mask:0xf
    v_dot2c_f32_bf16_dpp v72, v231, v232 row_newbcast:1 row_mask:0xf bank_mask:0xf
    v_dot2c_f32_bf16_dpp v73, v231, v233 row_newbcast:1 row_mask:0xf bank_mask:0xf
    v_dot2c_f32_bf16_dpp v74, v231, v234 row_newbcast:1 row_mask:0xf bank_mask:0xf
    v_dot2c_f32_bf16_dpp v75, v231, v235 row_newbcast:1 row_mask:0xf bank_mask:0xf
    v_dot2c_f32_bf16_dpp v76, v231, v236 row_newbcast:1 row_mask:0xf bank_mask:0xf
    v_dot2c_f32_bf16_dpp v77, v231, v237 row_newbcast:1 row_mask:0xf bank_mask:0xf
    v_dot2c_f32_bf16_dpp v78, v231, v238 row_newbcast:1 row_mask:0xf bank_mask:0xf
    v_dot2c_f32_bf16_dpp v79, v231, v239 row_newbcast:1 row_mask:0xf bank_mask:0xf
    v_dot2c_f32_bf16_dpp v80, v231, v232 row_newbcast:2 row_mask:0xf bank_mask:0xf
    v_dot2c_f32_bf16_dpp v81, v231, v233 row_newbcast:2 row_mask:0xf bank_mask:0xf
    v_dot2c_f32_bf16_dpp v82, v231, v234 row_newbcast:2 row_mask:0xf bank_mask:0xf
    v_dot2c_f32_bf16_dpp v83, v231, v235 row_newbcast:2 row_mask:0xf bank_mask:0xf
    v_dot2c_f32_bf16_dpp v84, v231, v236 row_newbcast:2 row_mask:0xf bank_mask:0xf
    v_dot2c_f32_bf16_dpp v85, v231, v237 row_newbcast:2 row_mask:0xf bank_mask:0xf
    v_dot2c_f32_bf16_dpp v86, v231, v238 row_newbcast:2 row_mask:0xf bank_mask:0xf
    v_dot2c_f32_bf16_dpp v87, v231, v239 row_newbcast:2 row_mask:0xf bank_mask:0xf
    v_dot2c_f32_bf16_dpp v88, v231, v232 row_newbcast:3 row_mask:0xf bank_mask:0xf
    v_dot2c_f32_bf16_dpp v89, v231, v233 row_newbcast:3 row_mask:0xf bank_mask:0xf
    v_dot2c_f32_bf16_dpp v90, v231, v234 row_newbcast:3 row_mask:0xf bank_mask:0xf
    v_dot2c_f32_bf16_dpp v91, v231, v235 row_newbcast:3 row_mask:0xf bank_mask:0xf
    v_dot2c_f32_bf16_dpp v92, v231, v236 row_newbcast:3 row_mask:0xf bank_mask:0xf
    v_dot2c_f32_bf16_dpp v93, v231, v237 row_newbcast:3 row_mask:0xf bank_mask:0xf
    v_dot2c_f32_bf16_dpp v94, v231, v238 row_newbcast:3 row_mask:0xf bank_mask:0xf
    v_dot2c_f32_bf16_dpp v95, v231, v239 row_newbcast:3 row_mask:0xf bank_mask:0xf
    v_dot2c_f32_bf16_dpp v96, v231, v232 row_newbcast:4 row_mask:0xf bank_mask:0xf
    v_dot2c_f32_bf16_dpp v97, v231, v233 row_newbcast:4 row_mask:0xf bank_mask:0xf
    v_dot2c_f32_bf16_dpp v98, v231, v234 row_newbcast:4 row_mask:0xf bank_mask:0xf
    v_dot2c_f32_bf16_dpp v99, v231, v235 row_newbcast:4 row_mask:0xf bank_mask:0xf
    v_dot2c_f32_bf16_dpp v100, v231, v236 row_newbcast:4 row_mask:0xf bank_mask:0xf
    v_dot2c_f32_bf16_dpp v101, v231, v237 row_newbcast:4 row_mask:0xf bank_mask:0xf
    v_dot2c_f32_bf16_dpp v102, v231, v238 row_newbcast:4 row_mask:0xf bank_mask:0xf
    v_dot2c_f32_bf16_dpp v103, v231, v239 row_newbcast:4 row_mask:0xf bank_mask:0xf
    v_dot2c_f32_bf16_dpp v104, v231, v232 row_newbcast:5 row_mask:0xf bank_mask:0xf
    v_dot2c_f32_bf16_dpp v105, v231, v233 row_newbcast:5 row_mask:0xf bank_mask:0xf
    v_dot2c_f32_bf16_dpp v106, v231, v234 row_newbcast:5 row_mask:0xf bank_mask:0xf
    v_dot2c_f32_bf16_dpp v107, v231, v235 row_newbcast:5 row_mask:0xf bank_mask:0xf
    v_dot2c_f32_bf16_dpp v108, v231, v236 row_newbcast:5 row_mask:0xf bank_mask:0xf
    v_dot2c_f32_bf16_dpp v109, v231, v237 row_newbcast:5 row_mask:0xf bank_mask:0xf
    v_dot2c_f32_bf16_dpp v110, v231, v238 row_newbcast:5 row_mask:0xf bank_mask:0xf
    v_dot2c_f32_bf16_dpp v111, v231, v239 row_newbcast:5 row_mask:0xf bank_mask:0xf
    v_dot2c_f32_bf16_dpp v112, v231, v232 row_newbcast:6 row_mask:0xf bank_mask:0xf
    v_dot2c_f32_bf16_dpp v113, v231, v233 row_newbcast:6 row_mask:0xf bank_mask:0xf
    v_dot2c_f32_bf16_dpp v114, v231, v234 row_newbcast:6 row_mask:0xf bank_mask:0xf
    v_dot2c_f32_bf16_dpp v115, v231, v235 row_newbcast:6 row_mask:0xf bank_mask:0xf
    v_dot2c_f32_bf16_dpp v116, v231, v236 row_newbcast:6 row_mask:0xf bank_mask:0xf
    v_dot2c_f32_bf16_dpp v117, v231, v237 row_newbcast:6 row_mask:0xf bank_mask:0xf
    v_dot2c_f32_bf16_dpp v118, v231, v238 row_newbcast:6 row_mask:0xf bank_mask:0xf
    v_dot2c_f32_bf16_dpp v119, v231, v239 row_newbcast:6 row_mask:0xf bank_mask:0xf
    v_dot2c_f32_bf16_dpp v120, v231, v232 row_newbcast:7 row_mask:0xf bank_mask:0xf
    v_dot2c_f32_bf16_dpp v121, v231, v233 row_newbcast:7 row_mask:0xf bank_mask:0xf
    v_dot2c_f32_bf16_dpp v122, v231, v234 row_newbcast:7 row_mask:0xf bank_mask:0xf
    v_dot2c_f32_bf16_dpp v123, v231, v235 row_newbcast:7 row_mask:0xf bank_mask:0xf
    v_dot2c_f32_bf16_dpp v124, v231, v236 row_newbcast:7 row_mask:0xf bank_mask:0xf
    v_dot2c_f32_bf16_dpp v125, v231, v237 row_newbcast:7 row_mask:0xf bank_mask:0xf
    v_dot2c_f32_bf16_dpp v126, v231, v238 row_newbcast:7 row_mask:0xf bank_mask:0xf
    v_dot2c_f32_bf16_dpp v127, v231, v239 row_newbcast:7 row_mask:0xf bank_mask:0xf
    s_sub_u32 s15, s15, 1
    s_cmp_lg_u32 s15, 0
    s_cbranch_scc1 L_attA
    v_mov_b32 v44, v28
    v_mov_b32 v45, v44
    s_nop 1
    v_permlane32_swap_b32 v44, v45
    v_max_f32 v44, v44, v45
    v_mov_b32 v45, v44
    s_nop 1
    v_permlane16_swap_b32 v44, v45
    v_max_f32 v44, v44, v45
    v_sub_f32 v46, v28, v44
    v_mul_f32 v46, s14, v46
    v_exp_f32 v46, v46
    s_nop 0
    v_mul_f32 v29, v46, v29
    s_nop 1
    v_add_f32_dpp v29, v29, v29 row_ror:8 row_mask:0xf bank_mask:0xf
    v_mov_b32 v45, v29
    s_nop 1
    v_permlane32_swap_b32 v29, v45
    v_add_f32 v29, v29, v45
    v_mov_b32 v45, v29
    s_nop 1
    v_permlane16_swap_b32 v29, v45
    v_add_f32 v29, v29, v45
    s_lshl_b32 s8, s78, 16
    s_lshl_b32 s9, s5, 10
    s_add_u32 s8, s8, s9
    s_add_u32 s8, s8, 327680
    s_mov_b32 s9, s8
    v_lshrrev_b32 v14, 1, v5
    v_mul_f32_dpp v64, v46, v64 row_newbcast:0 row_mask:0xf bank_mask:0xf
    v_mul_f32_dpp v65, v46, v65 row_newbcast:0 row_mask:0xf bank_mask:0xf
    v_mul_f32_dpp v66, v46, v66 row_newbcast:0 row_mask:0xf bank_mask:0xf
    v_mul_f32_dpp v67, v46, v67 row_newbcast:0 row_mask:0xf bank_mask:0xf
    v_mul_f32_dpp v68, v46, v68 row_newbcast:0 row_mask:0xf bank_mask:0xf
    v_mul_f32_dpp v69, v46, v69 row_newbcast:0 row_mask:0xf bank_mask:0xf
    v_mul_f32_dpp v70, v46, v70 row_newbcast:0 row_mask:0xf bank_mask:0xf
    v_mul_f32_dpp v71, v46, v71 row_newbcast:0 row_mask:0xf bank_mask:0xf
    v_permlane32_swap_b32 v64, v68
    v_permlane32_swap_b32 v65, v69
    v_permlane32_swap_b32 v66, v70
    v_permlane32_swap_b32 v67, v71
    v_add_f32 v64, v64, v68
    v_add_f32 v65, v65, v69
    v_add_f32 v66, v66, v70
    v_add_f32 v67, v67, v71
    s_nop 0
    v_permlane16_swap_b32 v64, v66
    v_permlane16_swap_b32 v65, v67
    v_add_f32 v64, v64, v66
    v_add_f32 v65, v65, v67
    v_and_or_b32 v64, v64, v15, s6
    v_and_or_b32 v65, v65, v15, s6
    buffer_store_dwordx2 v[64:65], v14, s[60:63], s9 offen sc1
    s_add_u32 s9, s9, 8192
    v_mul_f32_dpp v72, v46, v72 row_newbcast:1 row_mask:0xf bank_mask:0xf
    v_mul_f32_dpp v73, v46, v73 row_newbcast:1 row_mask:0xf bank_mask:0xf
    v_mul_f32_dpp v74, v46, v74 row_newbcast:1 row_mask:0xf bank_mask:0xf
    v_mul_f32_dpp v75, v46, v75 row_newbcast:1 row_mask:0xf bank_mask:0xf
    v_mul_f32_dpp v76, v46, v76 row_newbcast:1 row_mask:0xf bank_mask:0xf
    v_mul_f32_dpp v77, v46, v77 row_newbcast:1 row_mask:0xf bank_mask:0xf
    v_mul_f32_dpp v78, v46, v78 row_newbcast:1 row_mask:0xf bank_mask:0xf
    v_mul_f32_dpp v79, v46, v79 row_newbcast:1 row_mask:0xf bank_mask:0xf
    v_permlane32_swap_b32 v72, v76
    v_permlane32_swap_b32 v73, v77
    v_permlane32_swap_b32 v74, v78
    v_permlane32_swap_b32 v75, v79
    v_add_f32 v72, v72, v76
    v_add_f32 v73, v73, v77
    v_add_f32 v74, v74, v78
    v_add_f32 v75, v75, v79
    s_nop 0
    v_permlane16_swap_b32 v72, v74
    v_permlane16_swap_b32 v73, v75
    v_add_f32 v72, v72, v74
    v_add_f32 v73, v73, v75
    v_and_or_b32 v72, v72, v15, s6
    v_and_or_b32 v73, v73, v15, s6
    buffer_store_dwordx2 v[72:73], v14, s[60:63], s9 offen sc1
    s_add_u32 s9, s9, 8192
    v_mul_f32_dpp v80, v46, v80 row_newbcast:2 row_mask:0xf bank_mask:0xf
    v_mul_f32_dpp v81, v46, v81 row_newbcast:2 row_mask:0xf bank_mask:0xf
    v_mul_f32_dpp v82, v46, v82 row_newbcast:2 row_mask:0xf bank_mask:0xf
    v_mul_f32_dpp v83, v46, v83 row_newbcast:2 row_mask:0xf bank_mask:0xf
    v_mul_f32_dpp v84, v46, v84 row_newbcast:2 row_mask:0xf bank_mask:0xf
    v_mul_f32_dpp v85, v46, v85 row_newbcast:2 row_mask:0xf bank_mask:0xf
    v_mul_f32_dpp v86, v46, v86 row_newbcast:2 row_mask:0xf bank_mask:0xf
    v_mul_f32_dpp v87, v46, v87 row_newbcast:2 row_mask:0xf bank_mask:0xf
    v_permlane32_swap_b32 v80, v84
    v_permlane32_swap_b32 v81, v85
    v_permlane32_swap_b32 v82, v86
    v_permlane32_swap_b32 v83, v87
    v_add_f32 v80, v80, v84
    v_add_f32 v81, v81, v85
    v_add_f32 v82, v82, v86
    v_add_f32 v83, v83, v87
    s_nop 0
    v_permlane16_swap_b32 v80, v82
    v_permlane16_swap_b32 v81, v83
    v_add_f32 v80, v80, v82
    v_add_f32 v81, v81, v83
    v_and_or_b32 v80, v80, v15, s6
    v_and_or_b32 v81, v81, v15, s6
    buffer_store_dwordx2 v[80:81], v14, s[60:63], s9 offen sc1
    s_add_u32 s9, s9, 8192
    v_mul_f32_dpp v88, v46, v88 row_newbcast:3 row_mask:0xf bank_mask:0xf
    v_mul_f32_dpp v89, v46, v89 row_newbcast:3 row_mask:0xf bank_mask:0xf
    v_mul_f32_dpp v90, v46, v90 row_newbcast:3 row_mask:0xf bank_mask:0xf
    v_mul_f32_dpp v91, v46, v91 row_newbcast:3 row_mask:0xf bank_mask:0xf
    v_mul_f32_dpp v92, v46, v92 row_newbcast:3 row_mask:0xf bank_mask:0xf
    v_mul_f32_dpp v93, v46, v93 row_newbcast:3 row_mask:0xf bank_mask:0xf
    v_mul_f32_dpp v94, v46, v94 row_newbcast:3 row_mask:0xf bank_mask:0xf
    v_mul_f32_dpp v95, v46, v95 row_newbcast:3 row_mask:0xf bank_mask:0xf
    v_permlane32_swap_b32 v88, v92
    v_permlane32_swap_b32 v89, v93
    v_permlane32_swap_b32 v90, v94
    v_permlane32_swap_b32 v91, v95
    v_add_f32 v88, v88, v92
    v_add_f32 v89, v89, v93
    v_add_f32 v90, v90, v94
    v_add_f32 v91, v91, v95
    s_nop 0
    v_permlane16_swap_b32 v88, v90
    v_permlane16_swap_b32 v89, v91
    v_add_f32 v88, v88, v90
    v_add_f32 v89, v89, v91
    v_and_or_b32 v88, v88, v15, s6
    v_and_or_b32 v89, v89, v15, s6
    buffer_store_dwordx2 v[88:89], v14, s[60:63], s9 offen sc1
    s_add_u32 s9, s9, 8192
    v_mul_f32_dpp v96, v46, v96 row_newbcast:4 row_mask:0xf bank_mask:0xf
    v_mul_f32_dpp v97, v46, v97 row_newbcast:4 row_mask:0xf bank_mask:0xf
    v_mul_f32_dpp v98, v46, v98 row_newbcast:4 row_mask:0xf bank_mask:0xf
    v_mul_f32_dpp v99, v46, v99 row_newbcast:4 row_mask:0xf bank_mask:0xf
    v_mul_f32_dpp v100, v46, v100 row_newbcast:4 row_mask:0xf bank_mask:0xf
    v_mul_f32_dpp v101, v46, v101 row_newbcast:4 row_mask:0xf bank_mask:0xf
    v_mul_f32_dpp v102, v46, v102 row_newbcast:4 row_mask:0xf bank_mask:0xf
    v_mul_f32_dpp v103, v46, v103 row_newbcast:4 row_mask:0xf bank_mask:0xf
    v_permlane32_swap_b32 v96, v100
    v_permlane32_swap_b32 v97, v101
    v_permlane32_swap_b32 v98, v102
    v_permlane32_swap_b32 v99, v103
    v_add_f32 v96, v96, v100
    v_add_f32 v97, v97, v101
    v_add_f32 v98, v98, v102
    v_add_f32 v99, v99, v103
    s_nop 0
    v_permlane16_swap_b32 v96, v98
    v_permlane16_swap_b32 v97, v99
    v_add_f32 v96, v96, v98
    v_add_f32 v97, v97, v99
    v_and_or_b32 v96, v96, v15, s6
    v_and_or_b32 v97, v97, v15, s6
    buffer_store_dwordx2 v[96:97], v14, s[60:63], s9 offen sc1
    s_add_u32 s9, s9, 8192
    v_mul_f32_dpp v104, v46, v104 row_newbcast:5 row_mask:0xf bank_mask:0xf
    v_mul_f32_dpp v105, v46, v105 row_newbcast:5 row_mask:0xf bank_mask:0xf
    v_mul_f32_dpp v106, v46, v106 row_newbcast:5 row_mask:0xf bank_mask:0xf
    v_mul_f32_dpp v107, v46, v107 row_newbcast:5 row_mask:0xf bank_mask:0xf
    v_mul_f32_dpp v108, v46, v108 row_newbcast:5 row_mask:0xf bank_mask:0xf
    v_mul_f32_dpp v109, v46, v109 row_newbcast:5 row_mask:0xf bank_mask:0xf
    v_mul_f32_dpp v110, v46, v110 row_newbcast:5 row_mask:0xf bank_mask:0xf
    v_mul_f32_dpp v111, v46, v111 row_newbcast:5 row_mask:0xf bank_mask:0xf
    v_permlane32_swap_b32 v104, v108
    v_permlane32_swap_b32 v105, v109
    v_permlane32_swap_b32 v106, v110
    v_permlane32_swap_b32 v107, v111
    v_add_f32 v104, v104, v108
    v_add_f32 v105, v105, v109
    v_add_f32 v106, v106, v110
    v_add_f32 v107, v107, v111
    s_nop 0
    v_permlane16_swap_b32 v104, v106
    v_permlane16_swap_b32 v105, v107
    v_add_f32 v104, v104, v106
    v_add_f32 v105, v105, v107
    v_and_or_b32 v104, v104, v15, s6
    v_and_or_b32 v105, v105, v15, s6
    buffer_store_dwordx2 v[104:105], v14, s[60:63], s9 offen sc1
    s_add_u32 s9, s9, 8192
    v_mul_f32_dpp v112, v46, v112 row_newbcast:6 row_mask:0xf bank_mask:0xf
    v_mul_f32_dpp v113, v46, v113 row_newbcast:6 row_mask:0xf bank_mask:0xf
    v_mul_f32_dpp v114, v46, v114 row_newbcast:6 row_mask:0xf bank_mask:0xf
    v_mul_f32_dpp v115, v46, v115 row_newbcast:6 row_mask:0xf bank_mask:0xf
    v_mul_f32_dpp v116, v46, v116 row_newbcast:6 row_mask:0xf bank_mask:0xf
    v_mul_f32_dpp v117, v46, v117 row_newbcast:6 row_mask:0xf bank_mask:0xf
    v_mul_f32_dpp v118, v46, v118 row_newbcast:6 row_mask:0xf bank_mask:0xf
    v_mul_f32_dpp v119, v46, v119 row_newbcast:6 row_mask:0xf bank_mask:0xf
    v_permlane32_swap_b32 v112, v116
    v_permlane32_swap_b32 v113, v117
    v_permlane32_swap_b32 v114, v118
    v_permlane32_swap_b32 v115, v119
    v_add_f32 v112, v112, v116
    v_add_f32 v113, v113, v117
    v_add_f32 v114, v114, v118
    v_add_f32 v115, v115, v119
    s_nop 0
    v_permlane16_swap_b32 v112, v114
    v_permlane16_swap_b32 v113, v115
    v_add_f32 v112, v112, v114
    v_add_f32 v113, v113, v115
    v_and_or_b32 v112, v112, v15, s6
    v_and_or_b32 v113, v113, v15, s6
    buffer_store_dwordx2 v[112:113], v14, s[60:63], s9 offen sc1
    s_add_u32 s9, s9, 8192
    v_mul_f32_dpp v120, v46, v120 row_newbcast:7 row_mask:0xf bank_mask:0xf
    v_mul_f32_dpp v121, v46, v121 row_newbcast:7 row_mask:0xf bank_mask:0xf
    v_mul_f32_dpp v122, v46, v122 row_newbcast:7 row_mask:0xf bank_mask:0xf
    v_mul_f32_dpp v123, v46, v123 row_newbcast:7 row_mask:0xf bank_mask:0xf
    v_mul_f32_dpp v124, v46, v124 row_newbcast:7 row_mask:0xf bank_mask:0xf
    v_mul_f32_dpp v125, v46, v125 row_newbcast:7 row_mask:0xf bank_mask:0xf
    v_mul_f32_dpp v126, v46, v126 row_newbcast:7 row_mask:0xf bank_mask:0xf
    v_mul_f32_dpp v127, v46, v127 row_newbcast:7 row_mask:0xf bank_mask:0xf
    v_permlane32_swap_b32 v120, v124
    v_permlane32_swap_b32 v121, v125
    v_permlane32_swap_b32 v122, v126
    v_permlane32_swap_b32 v123, v127
    v_add_f32 v120, v120, v124
    v_add_f32 v121, v121, v125
    v_add_f32 v122, v122, v126
    v_add_f32 v123, v123, v127
    s_nop 0
    v_permlane16_swap_b32 v120, v122
    v_permlane16_swap_b32 v121, v123
    v_add_f32 v120, v120, v122
    v_add_f32 v121, v121, v123
    v_and_or_b32 v120, v120, v15, s6
    v_and_or_b32 v121, v121, v15, s6
    buffer_store_dwordx2 v[120:121], v14, s[60:63], s9 offen sc1
    s_add_u32 s9, s9, 8192
    v_mov_b32 v45, v29
    v_lshlrev_b32 v13, 13, v0
    v_and_b32 v46, 0xff, v44
    v_lshl_or_b32 v46, v46, 8, s6
    v_mov_b32 v47, s6
    v_and_or_b32 v44, v44, v15, s6
    v_and_or_b32 v45, v45, v15, s6
    s_mov_b64 exec, 0xff
    buffer_store_dwordx4 v[44:47], v13, s[60:63], s8 offen offset:512 sc1
L_end:
    s_endpgm
.section .rodata,"a"
.p2align 6
.amdhsa_kernel concat_heads__sliding_block_cached__mha_block_cached__decode_kernel
  .amdhsa_next_free_vgpr 256
  .amdhsa_next_free_sgpr 102
  .amdhsa_accum_offset 256
  .amdhsa_group_segment_fixed_size 0
  .amdhsa_kernarg_size 104
  .amdhsa_user_sgpr_count 2
  .amdhsa_user_sgpr_kernarg_segment_ptr 1
  .amdhsa_system_sgpr_workgroup_id_x 1
.end_amdhsa_kernel
```
